```python
import torch

def _softmax(x, axis=-1):
    return torch.softmax(x, dim=axis)
def _gelu(x):
    return torch.nn.functional.gelu(x, approximate="tanh")
def _silu(x):
    return torch.nn.functional.silu(x)
def _sigmoid(x):
    return torch.sigmoid(x)
def _layernorm(x, axis=-1, eps=1e-5):
    m = x.mean(dim=axis, keepdim=True)
    v = x.var(dim=axis, keepdim=True, unbiased=False)
    return (x - m) / torch.sqrt(v + eps)
def _scatter_add(tgt, idx, src, axis=0):
    return tgt.clone().index_add_(axis, idx, src)
def _segment_sum(src, seg, n):
    out = torch.zeros((n,) + src.shape[1:], dtype=src.dtype)
    return out.index_add_(0, seg, src)
def _pad(x, pw):
    flat = tuple(v for pair in reversed(pw) for v in pair)
    return torch.nn.functional.pad(x, flat)

kernel_name = 'sequential_preLN__sliding_local_dilated__glu_gated_swiglu__prompt'

def setup_inputs():

    _w = (lambda a: (lambda t: t.to(torch.bfloat16) if t.is_floating_point() else t)(torch.as_tensor(a)))
    def _A_setup():
        B, S, D = 1, 2048, 448
        return {
            "x": _w((lambda *s: torch.randn(*s, dtype=torch.bfloat16) * 0.05)(B, S, D)),
            "wqkv": _w((lambda *s: torch.randn(*s, dtype=torch.bfloat16) * 0.05)(D, 3 * D)),
            "wo": _w((lambda *s: torch.randn(*s, dtype=torch.bfloat16) * 0.05)(D, D)),
        }
    _A_in = _A_setup()

    def _B_setup():
        B, S, D, F = 1, 2048, 448, 1792
        return {
            "x": _w((lambda *s: torch.randn(*s, dtype=torch.bfloat16) * 0.05)(B, S, D)),
            "w1": _w((lambda *s: torch.randn(*s, dtype=torch.bfloat16) * 0.8)(D, F) * (2.0 / D) ** 0.5),
            "w3": _w((lambda *s: torch.randn(*s, dtype=torch.bfloat16) * 0.8)(D, F) * (2.0 / D) ** 0.5),
            "w2": _w((lambda *s: torch.randn(*s, dtype=torch.bfloat16) * 0.8)(F, D) * (2.0 / F) ** 0.5),
        }
    _B_in = _B_setup()

    return {
        "A_x": _A_in["x"],
        "A_wqkv": _A_in["wqkv"],
        "A_wo": _A_in["wo"],
        "B_x": _B_in["x"],
        "B_w1": _B_in["w1"],
        "B_w3": _B_in["w3"],
        "B_w2": _B_in["w2"],
    }

def reference(A_x, A_wqkv, A_wo, B_x, B_w1, B_w3, B_w2):
    def _A_ref(x, wqkv, wo):
        B, S, D = x.shape
        H = 16; Dh = D // H
        W, dil = 8, 2
        qkv = (lambda x, *d: x.permute(*d))((x @ wqkv).reshape(B, S, 3, H, Dh), 2, 0, 3, 1, 4)
        q, k, v = qkv[0], qkv[1], qkv[2]
        scale = Dh ** -0.5
        pos = torch.arange(S)
        off = torch.arange(W) * dil
        idx = pos[:, None] - off[None, :]
        mask = idx >= 0
        idx_c = torch.where(mask, idx, 0).reshape(-1)
        kg = k[:, :, idx_c, :].reshape(B, H, S, W, Dh)
        vg = v[:, :, idx_c, :].reshape(B, H, S, W, Dh)
        logits = torch.einsum("bhsd,bhswd->bhsw", q, kg) * scale
        logits = torch.where(mask[None, None, :, :], logits, -1e9)
        attn = _softmax(logits, axis=-1)
        o = torch.einsum("bhsw,bhswd->bhsd", attn, vg)
        return (lambda x, *d: x.permute(*d))(o, 0, 2, 1, 3).reshape(B, S, D) @ wo

    def _B_ref(x, w1, w3, w2):
        gate = torch.einsum("bsd,df->bsf", x, w1)
        up = torch.einsum("bsd,df->bsf", x, w3)
        h = _silu(gate) * up
        out = torch.einsum("bsf,fd->bsd", h, w2)
        return out

    x = A_x
    h = x + _A_ref(_layernorm(x, axis=-1), A_wqkv, A_wo)
    h2 = h + _B_ref(_layernorm(h, axis=-1), B_w1, B_w3, B_w2)
    return h2
```

```asm
; @launch grid=(256,1,1) block=(256,1,1) lds=163840
.amdgcn_target "amdgcn-amd-amdhsa--gfx950"
.text
.globl sequential_preLN__sliding_local_dilated__glu_gated_swiglu__prompt_kernel
.p2align 8
.type sequential_preLN__sliding_local_dilated__glu_gated_swiglu__prompt_kernel,@function
sequential_preLN__sliding_local_dilated__glu_gated_swiglu__prompt_kernel:
    s_cmp_ge_u32 s2, 256
    s_cbranch_scc1 k_end_1
    s_load_dwordx16 s[4:19], s[0:1], 0
    s_load_dwordx4 s[20:23], s[0:1], 64
    s_getpc_b64 s[62:63]
    v_min_u32 v2, 236, v0
    v_lshlrev_b32_e64 v2, 7, v2
    global_load_dword v3, v2, s[62:63]
    v_lshrrev_b32 v1, 6, v0
    v_and_b32 v0, 63, v0
    v_readfirstlane_b32 s48, v1
    v_mov_b32 v4, 1
    v_mov_b32 v5, 0
    v_lshlrev_b32 v6, 4, v0
    v_mov_b32 v10, 0x3f803f80
    s_and_b32 s49, s2, 7
    s_lshr_b32 s50, s2, 3
    s_lshr_b32 s53, s49, 1
    s_lshl_b32 s53, s53, 2
    s_lshr_b32 s51, s50, 3
    s_add_u32 s53, s53, s51
    s_and_b32 s54, s49, 1
    s_lshl_b32 s54, s54, 3
    s_and_b32 s51, s50, 7
    s_add_u32 s54, s54, s51
    s_lshl_b32 s55, s48, 10
    s_mul_i32 s56, s48, 1056
    s_add_u32 s56, s56, 18432
    s_mul_i32 s57, s48, 43008
    s_and_b32 s49, s48, 1
    s_lshl_b32 s49, s49, 3
    v_lshrrev_b32 v122, 3, v0
    v_add_u32 v123, s49, v122
    v_lshrrev_b32 v123, 1, v123
    v_add_u32 v123, 6, v123
    v_and_b32 v124, 7, v0
    v_xor_b32 v123, v123, v124
    v_and_b32 v123, 7, v123
    v_lshlrev_b32 v123, 4, v123
    s_lshl_b32 s49, s53, 7
    s_lshl_b32 s50, s48, 3
    s_add_u32 s49, s49, s50
    s_sub_u32 s49, s49, 16
    v_add_u32 v122, s49, v122
    v_add_u32 v124, 32, v122
    v_max_i32 v122, 0, v122
    v_mul_u32_u24 v122, 896, v122
    v_add_u32_e64 v108, v122, v123
    v_mul_u32_u24 v124, 896, v124
    v_add_u32_e64 v109, v124, v123
    v_add_u32 v110, 28672, v109
    v_add_u32 v111, 57344, v109
    v_add_u32 v112, 86016, v109
    v_lshrrev_b32_e64 v122, 2, v0
    v_mul_u32_u24 v122, 2688, v122
    v_and_b32_e64 v123, 3, v0
    v_lshl_add_u32 v122, v123, 4, v122
    s_mul_i32 s49, s54, 56
    s_add_u32 s49, s49, s57
    v_add_u32_e64 v113, s49, v122
    v_add_u32 v114, 896, v113
    v_add_u32 v115, 1792, v113
    s_mov_b32 s49, 0x42312010
    s_mov_b32 s50, 0x68574635
    s_cmp_ge_u32 s54, 8
    s_cselect_b32 s49, s50, s49
    s_and_b32 s50, s54, 7
    s_lshl_b32 s50, s50, 2
    s_lshr_b32 s49, s49, s50
    s_and_b32 s49, s49, 15
    s_lshr_b32 s50, 0xaa54, s54
    s_and_b32 s50, s50, 1
    s_mul_i32 s51, s53, 9
    s_add_u32 s51, s51, s49
    s_cmp_ge_u32 s51, 112
    s_cmov_b32 s51, 255
    s_mul_i32 s52, s53, 7
    s_add_u32 s52, s52, s49
    s_add_u32 s52, s52, 112
    s_cmp_eq_u32 s50, 1
    s_cselect_b32 s100, s52, s51
    s_waitcnt lgkmcnt(0)
    s_mov_b32 s24, s4
    s_and_b32 s25, s5, 0xffff
    s_mov_b32 s26, 1835008
    s_mov_b32 s27, 0x20000
    s_mov_b32 s28, s6
    s_and_b32 s29, s7, 0xffff
    s_mov_b32 s30, 1204224
    s_mov_b32 s31, 0x20000
    s_mov_b32 s32, s22
    s_and_b32 s33, s23, 0xffff
    s_mov_b32 s34, 17301504
    s_mov_b32 s35, 0x20000
    s_mov_b32 s44, s20
    s_and_b32 s45, s21, 0xffff
    s_mov_b32 s46, 256
    s_mov_b32 s47, 0x20000
    s_cmp_lg_u32 s2, 0
    s_cbranch_scc1 nozero_3
    v_mov_b32 v128, 0
    v_mov_b32 v129, 0
    v_mov_b32 v130, 0
    v_mov_b32_e64 v131, 0
    s_lshl_b32 s49, s48, 10
    s_add_u32 s49, s49, 16777216
    buffer_store_dwordx4 v[128:131], v6, s[32:35], s49 offen sc1
    s_add_u32 s49, s49, 4096
    buffer_store_dwordx4 v[128:131], v6, s[32:35], s49 offen sc1
    s_add_u32 s49, s49, 4096
    buffer_store_dwordx4 v[128:131], v6, s[32:35], s49 offen sc1
    s_add_u32 s49, s49, 4096
    buffer_store_dwordx4 v[128:131], v6, s[32:35], s49 offen sc1
    s_add_u32 s49, s49, 4096
    buffer_store_dwordx4 v[128:131], v6, s[32:35], s49 offen sc1
    s_add_u32 s49, s49, 4096
    buffer_store_dwordx4 v[128:131], v6, s[32:35], s49 offen sc1
    s_add_u32 s49, s49, 4096
    buffer_store_dwordx4 v[128:131], v6, s[32:35], s49 offen sc1
    s_add_u32 s49, s49, 4096
    buffer_store_dwordx4 v[128:131], v6, s[32:35], s49 offen sc1
    s_add_u32 s49, s49, 4096
nozero_3:
    s_lshl_b32 s10, s2, 2
    s_add_u32 s10, s10, s48
    s_lshl_b32 s10, s10, 10
    s_add_u32 s11, s10, 1048576
    s_mov_b32 s20, 0
    s_mov_b32 s21, 0
    s_add_u32 m0, s56, 0
    s_nop 0
    buffer_load_dwordx4 v113, s[28:31], s21 offen lds
    s_add_u32 m0, s55, 0
    s_nop 0
    buffer_load_dwordx4 v108, s[24:27], s20 offen lds
    s_add_u32 m0, s56, 4224
    s_nop 0
    buffer_load_dwordx4 v114, s[28:31], s21 offen lds
    s_add_u32 m0, s55, 4096
    s_nop 0
    buffer_load_dwordx4 v109, s[24:27], s20 offen lds
    s_add_u32 m0, s55, 8192
    s_nop 0
    buffer_load_dwordx4 v110, s[24:27], s20 offen lds
    s_add_u32 m0, s55, 12288
    s_nop 0
    buffer_load_dwordx4 v111, s[24:27], s20 offen lds
    s_add_u32 m0, s55, 16384
    s_cmp_ge_u32 s48, 2
    s_cbranch_scc1 p1_skipx_4
    buffer_load_dwordx4 v112, s[24:27], s20 offen lds
p1_skipx_4:
    s_add_u32 m0, s56, 8448
    s_nop 0
    buffer_load_dwordx4 v115, s[28:31], s21 offen lds
    s_mov_b32 m0, 156544
    s_nop 0
    s_nop 0
    buffer_load_dwordx4 v6, s[28:31], s10 offen lds
    buffer_load_dwordx4 v6, s[28:31], s11 offen lds
    buffer_load_dwordx4 v6, s[24:27], s10 offen lds
    buffer_load_dwordx4 v6, s[24:27], s11 offen lds
    s_mov_b32 s22, 128
    s_mov_b32 s23, 172032
    s_add_u32 m0, s56, 31104
    s_nop 0
    buffer_load_dwordx4 v113, s[28:31], s23 offen lds
    s_mov_b32 s40, s18
    s_and_b32 s41, s19, 0xffff
    s_mov_b32 s42, 1835008
    s_mov_b32 s43, 0x20000
    s_mov_b32 s4, s8
    s_and_b32 s5, s9, 0xffff
    s_mov_b32 s6, 401408
    s_mov_b32 s7, 0x20000
    v_bfe_u32 v122, v0, 4, 1
    v_lshlrev_b32 v122, 1, v122
    v_lshrrev_b32 v123, 5, v0
    v_or_b32 v122, v122, v123
    v_and_b32 v123, 15, v0
    v_lshrrev_b32 v124, 1, v123
    v_add_u32 v124, 6, v124
    v_and_b32 v124, 7, v124
    v_xor_b32 v124, v124, v122
    v_lshlrev_b32 v124, 4, v124
    v_lshl_add_u32 v124, v123, 7, v124
    s_lshl_b32 s49, s48, 12
    v_add_u32 v116, s49, v124
    v_xor_b32 v117, 64, v116
    v_lshrrev_b32 v123, 1, v122
    v_mul_u32_u24 v124, 1056, v123
    s_add_u32 m0, s55, 31104
    s_nop 0
    buffer_load_dwordx4 v108, s[24:27], s22 offen lds
    v_and_b32 v123, 1, v122
    v_lshl_add_u32 v124, v123, 9, v124
    v_bfe_u32 v123, v0, 2, 2
    v_lshl_add_u32 v124, v123, 6, v124
    v_and_b32_e64 v123, 3, v0
    v_lshl_add_u32 v124, v123, 3, v124
    v_add_u32 v118, 18432, v124
    v_and_b32_e64 v122, 15, v0
    v_cmp_eq_u32 s[62:63], 0, v122
    v_cmp_gt_u32 s[64:65], 48, v0
    v_cmp_lt_u32 s[68:69], 11, v122
    v_lshrrev_b32 v123, 4, v0
    v_lshlrev_b32 v123, 2, v123
    v_sub_u32_e64 v123, v122, v123
    v_cmp_eq_u32 s[70:71], 0, v123
    v_cmp_eq_u32 s[72:73], 1, v123
    v_cmp_eq_u32 s[74:75], 2, v123
    v_cmp_eq_u32 s[76:77], 3, v123
    v_mov_b32_e64 v126, v123
    v_mov_b32 v125, 0xf149f2ca
    s_or_b32 s49, s53, s48
    s_cmp_eq_u32 s49, 0
    s_cselect_b64 s[66:67], -1, 0
    v_subrev_u32 v122, 0, v126
    s_add_u32 m0, s56, 35328
    s_nop 0
    buffer_load_dwordx4 v114, s[28:31], s23 offen lds
    v_and_b32 v123, 1, v122
    v_cmp_eq_u32 vcc, 0, v123
    s_nop 1
    v_cndmask_b32 v124, v125, 0, vcc
    v_cmp_gt_i32 vcc, 0, v122
    s_nop 1
    v_cndmask_b32 v96, v125, v124, vcc
    v_cndmask_b32 v100, v124, v125, vcc
    v_cndmask_b32 v104, v96, v125, s[66:67]
    v_subrev_u32 v122, 1, v126
    v_and_b32 v123, 1, v122
    v_cmp_eq_u32 vcc, 0, v123
    s_nop 1
    v_cndmask_b32 v124, v125, 0, vcc
    v_cmp_gt_i32 vcc, 0, v122
    s_nop 1
    v_cndmask_b32 v97, v125, v124, vcc
    v_cndmask_b32 v101, v124, v125, vcc
    v_cndmask_b32 v105, v97, v125, s[66:67]
    v_subrev_u32 v122, 2, v126
    v_and_b32 v123, 1, v122
    v_cmp_eq_u32 vcc, 0, v123
    s_nop 1
    v_cndmask_b32 v124, v125, 0, vcc
    v_cmp_gt_i32 vcc, 0, v122
    s_nop 1
    v_cndmask_b32 v98, v125, v124, vcc
    v_cndmask_b32 v102, v124, v125, vcc
    v_cndmask_b32 v106, v98, v125, s[66:67]
    v_subrev_u32_e64 v122, 3, v126
    s_add_u32 m0, s55, 35200
    s_nop 0
    buffer_load_dwordx4 v109, s[24:27], s22 offen lds
    v_and_b32 v123, 1, v122
    v_cmp_eq_u32 vcc, 0, v123
    s_nop 1
    v_cndmask_b32 v124, v125, 0, vcc
    v_cmp_gt_i32 vcc, 0, v122
    s_nop 1
    v_cndmask_b32 v99, v125, v124, vcc
    v_cndmask_b32 v103, v124, v125, vcc
    v_cndmask_b32 v107, v99, v125, s[66:67]
    s_lshl_b32 s49, s48, 6
    s_add_u32 s50, s49, 0
    v_add_u32_e64 v129, s50, v0
    v_mul_u32_u24 v130, 4682, v129
    v_lshrrev_b32 v130, 16, v130
    v_mul_u32_u24 v122, 14, v130
    v_sub_u32_e64 v129, v129, v122
    v_mul_u32_u24 v130, 896, v130
    v_lshl_add_u32 v122, v129, 4, v130
    s_add_u32 s50, s49, 256
    v_add_u32_e64 v129, s50, v0
    v_mul_u32_u24 v130, 4682, v129
    v_lshrrev_b32 v130, 16, v130
    v_mul_u32_u24 v123, 14, v130
    v_sub_u32_e64 v129, v129, v123
    v_mul_u32_u24 v130, 896, v130
    v_lshl_add_u32 v123, v129, 4, v130
    s_add_u32 m0, s55, 39296
    s_nop 0
    buffer_load_dwordx4 v110, s[24:27], s22 offen lds
    s_add_u32 s50, s49, 512
    v_add_u32 v129, s50, v0
    v_mul_u32_u24 v130, 4682, v129
    v_lshrrev_b32 v130, 16, v130
    v_mul_u32_u24 v124, 14, v130
    v_sub_u32_e64 v129, v129, v124
    v_mul_u32_u24 v130, 896, v130
    v_lshl_add_u32 v124, v129, 4, v130
    s_add_u32 s50, s49, 768
    v_add_u32_e64 v129, s50, v0
    v_mul_u32_u24 v130, 4682, v129
    v_lshrrev_b32 v130, 16, v130
    v_mul_u32_u24 v125, 14, v130
    v_sub_u32_e64 v129, v129, v125
    v_mul_u32_u24 v130, 896, v130
    v_lshl_add_u32 v125, v129, 4, v130
    s_add_u32 s50, s49, 1024
    v_add_u32_e64 v129, s50, v0
    v_mul_u32_u24 v130, 4682, v129
    v_lshrrev_b32 v130, 16, v130
    v_mul_u32_u24 v126, 14, v130
    v_sub_u32_e64 v129, v129, v126
    v_mul_u32_u24 v130, 896, v130
    v_lshl_add_u32 v126, v129, 4, v130
    s_add_u32 m0, s55, 43392
    s_nop 0
    buffer_load_dwordx4 v111, s[24:27], s22 offen lds
    s_add_u32 s50, s49, 1280
    v_add_u32 v129, s50, v0
    v_mul_u32_u24 v130, 4682, v129
    v_lshrrev_b32 v130, 16, v130
    v_mul_u32_u24 v127, 14, v130
    v_sub_u32_e64 v129, v129, v127
    v_mul_u32_u24 v130, 896, v130
    v_lshl_add_u32 v127, v129, 4, v130
    s_add_u32 s50, s49, 1536
    v_add_u32_e64 v129, s50, v0
    v_mul_u32_u24 v130, 4682, v129
    v_lshrrev_b32 v130, 16, v130
    v_mul_u32_u24 v128, 14, v130
    v_sub_u32_e64 v129, v129, v128
    v_mul_u32_u24 v130, 896, v130
    v_lshl_add_u32 v128, v129, 4, v130
    s_lshr_b32 s50, s2, 3
    s_and_b32 s50, s50, 3
    s_mul_i32 s85, s50, 224
    s_lshl_b32 s99, s48, 10
    s_add_u32 s99, s99, 62208
    s_lshl_b32 s97, s53, 2
    s_add_u32 s97, s97, s48
    s_mul_i32 s50, s53, 256
    s_add_u32 m0, s55, 47488
    s_cmp_ge_u32 s48, 2
    s_cbranch_scc1 p1_skipx_5
    buffer_load_dwordx4 v112, s[24:27], s22 offen lds
p1_skipx_5:
    s_add_u32 s88, s50, 16777216
    s_lshr_b32 s51, s54, 2
    s_lshl_b32 s51, s51, 4
    s_add_u32 s50, s50, s51
    s_add_u32 s96, s50, 16793600
    s_mul_i32 s60, s54, 196
    s_mul_i32 s89, s48, 7
    s_add_u32 s60, s60, s89
    s_lshl_b32 s60, s60, 10
    s_add_u32 s60, s60, 458752
    s_lshl_b32 s89, s89, 10
    s_lshr_b32 s49, s97, 1
    s_lshl_b32 s49, s49, 2
    s_lshr_b32 s50, s54, 2
    s_add_u32 s49, s49, s50
    s_mul_i32 s95, s49, 56
    s_and_b32 s49, s54, 3
    s_lshl_b32 s49, s49, 1
    s_add_u32 s95, s95, s49
    s_and_b32 s49, s97, 1
    s_add_u32 s95, s95, s49
    s_lshl_b32 s95, s95, 10
    s_add_u32 s95, s95, 9306112
    s_and_b32 s49, s2, 7
    s_add_u32 m0, s56, 39552
    s_nop 0
    buffer_load_dwordx4 v115, s[28:31], s23 offen lds
    s_lshr_b32 s50, s2, 3
    s_lshl_b32 s92, s49, 3
    s_lshr_b32 s51, s50, 2
    s_add_u32 s92, s92, s51
    s_and_b32 s93, s50, 3
    s_and_b32 s90, s48, 1
    s_lshr_b32 s91, s48, 1
    s_lshr_b32 s94, s92, 2
    s_mul_i32 s94, s94, 256
    s_add_u32 s94, s94, 16785408
    s_mul_i32 s51, s50, 37
    s_lshr_b32 s51, s51, 8
    s_mul_i32 s52, s51, 7
    s_sub_u32 s84, s50, s52
    s_lshl_b32 s83, s49, 2
    s_add_u32 s83, s83, s51
    s_lshl_b32 s81, s84, 2
    s_add_u32 s81, s81, s48
    s_mul_i32 s81, s81, 57344
    s_add_u32 s81, s81, 3670016
    s_lshl_b32 s82, s83, 2
    s_add_u32 s82, s82, s48
    s_mul_i32 s82, s82, 57344
    s_add_u32 s82, s82, 9306112
    s_mul_i32 s49, s54, 7
    s_add_u32 s50, s49, 6
    s_lshr_b32 s49, s49, 2
    s_lshr_b32 s50, s50, 2
    v_bfe_u32 v129, v0, 2, 2
    v_add_u32 v129, s49, v129
    v_min_u32 v129, s50, v129
    v_lshlrev_b32 v129, 7, v129
    v_add_u32 v129, 16801792, v129
    s_lshl_b32 s49, s84, 7
    s_add_u32 s49, s49, 16805888
    v_mov_b32 v8, s49
    v_and_b32 v130, 16, v0
    v_cmp_eq_u32 vcc, 0, v130
    s_nop 1
    v_cndmask_b32 v8, v8, v129, vcc
    v_and_b32 v9, 15, v0
    v_lshlrev_b32 v9, 2, v9
    v_add_u32 v129, 162560, v6
    v_mov_b32 v132, 0
    v_mov_b32 v133, 0
    v_mov_b32 v134, 0
    v_mov_b32 v135, 0
    ds_write_b128 v129, v[132:135]
    s_waitcnt vmcnt(11)
    s_barrier
    s_or_b32 s49, s2, s48
    s_cmp_lg_u32 s49, 0
    s_cbranch_scc1 noinit_6
    v_mov_b32 v7, 0x01010101
    s_movk_i32 s49, 252
    s_mov_b64 exec, 1
    buffer_store_dword v7, v5, s[44:47], s49 offen sc1
    s_mov_b64 exec, -1
noinit_6:
    v_add_u32 v119, 0, v116
    v_add_u32 v120, 0, v117
    v_add_u32_e64 v121, 0, v118
    ds_read_b128 v[184:187], v119 offset:2048
    ds_read_b128 v[188:191], v119 offset:4096
    ds_read_b128 v[180:183], v119 offset:0
    ds_read_b64_tr_b16 v[132:133], v121 offset:0
    ds_read_b64_tr_b16 v[134:135], v121 offset:256
    ds_read_b64_tr_b16 v[136:137], v121 offset:32
    ds_read_b64_tr_b16 v[138:139], v121 offset:288
    ds_read_b64_tr_b16 v[140:141], v121 offset:4224
    ds_read_b64_tr_b16 v[142:143], v121 offset:4480
    ds_read_b64_tr_b16 v[144:145], v121 offset:4256
    ds_read_b64_tr_b16 v[146:147], v121 offset:4512
    ds_read_b64_tr_b16 v[148:149], v121 offset:8448
    ds_read_b64_tr_b16 v[150:151], v121 offset:8704
    ds_read_b64_tr_b16 v[152:153], v121 offset:8480
    ds_read_b64_tr_b16 v[154:155], v121 offset:8736
    s_waitcnt lgkmcnt(0)
    s_nop 0
    v_mfma_f32_16x16x32_bf16 v[20:23], v[132:135], v[184:187], 0
    v_cndmask_b32 v180, v180, v10, s[62:63]
    ds_read_b128 v[196:199], v120 offset:2048
    s_mov_b32 s20, 256
    s_mov_b32 s21, 344064
    s_add_u32 m0, s56, 62208
    v_mfma_f32_16x16x32_bf16 v[24:27], v[136:139], v[184:187], 0
    buffer_load_dwordx4 v113, s[28:31], s21 offen lds
    v_cndmask_b32 v181, v181, v10, s[62:63]
    v_mfma_f32_16x16x32_bf16 v[44:47], v[140:143], v[184:187], 0
    v_cndmask_b32 v182, v182, v10, s[62:63]
    ds_read_b128 v[200:203], v120 offset:4096
    v_mfma_f32_16x16x32_bf16 v[68:71], v[184:187], v[148:151], 0
    v_cndmask_b32 v183, v183, v10, s[62:63]
    s_add_u32 m0, s55, 62208
    v_mfma_f32_16x16x32_bf16 v[72:75], v[184:187], v[152:155], 0
    buffer_load_dwordx4 v108, s[24:27], s20 offen lds
    v_cndmask_b32 v144, v144, v10, s[68:69]
    ds_read_b128 v[192:195], v120 offset:0
    v_mfma_f32_16x16x32_bf16 v[88:91], v[184:187], v[184:187], 0
    v_cndmask_b32 v145, v145, v10, s[68:69]
    v_mfma_f32_16x16x32_bf16 v[28:31], v[132:135], v[188:191], 0
    v_cndmask_b32 v146, v146, v10, s[68:69]
    ds_read_b64_tr_b16 v[156:157], v121 offset:2112
    v_mfma_f32_16x16x32_bf16 v[32:35], v[136:139], v[188:191], 0
    v_cndmask_b32 v147, v147, v10, s[68:69]
    s_add_u32 m0, s56, 66432
    v_mfma_f32_16x16x32_bf16 v[52:55], v[140:143], v[188:191], 0
    buffer_load_dwordx4 v114, s[28:31], s21 offen lds
    ds_read_b64_tr_b16 v[158:159], v121 offset:2368
    v_mfma_f32_16x16x32_bf16 v[76:79], v[188:191], v[148:151], 0
    ds_read_b64_tr_b16 v[160:161], v121 offset:2144
    ds_read_b64_tr_b16 v[162:163], v121 offset:2400
    v_mfma_f32_16x16x32_bf16 v[80:83], v[188:191], v[152:155], 0
    ds_read_b64_tr_b16 v[164:165], v121 offset:6336
    v_mfma_f32_16x16x32_bf16 v[92:95], v[188:191], v[188:191], 0
    ds_read_b64_tr_b16 v[166:167], v121 offset:6592
    ds_read_b64_tr_b16 v[168:169], v121 offset:6368
    s_add_u32 m0, s55, 66304
    v_mfma_f32_16x16x32_bf16 v[48:51], v[144:147], v[184:187], 0
    buffer_load_dwordx4 v109, s[24:27], s20 offen lds
    ds_read_b64_tr_b16 v[170:171], v121 offset:6624
    v_mfma_f32_16x16x32_bf16 v[56:59], v[144:147], v[188:191], 0
    ds_read_b64_tr_b16 v[172:173], v121 offset:10560
    ds_read_b64_tr_b16 v[174:175], v121 offset:10816
    v_mfma_f32_16x16x32_bf16 v[12:15], v[132:135], v[180:183], 0
    ds_read_b64_tr_b16 v[176:177], v121 offset:10592
    v_mfma_f32_16x16x32_bf16 v[16:19], v[136:139], v[180:183], 0
    ds_read_b64_tr_b16 v[178:179], v121 offset:10848
    s_add_u32 m0, s55, 70400
    v_mfma_f32_16x16x32_bf16 v[36:39], v[140:143], v[180:183], 0
    buffer_load_dwordx4 v110, s[24:27], s20 offen lds
    v_mfma_f32_16x16x32_bf16 v[40:43], v[144:147], v[180:183], 0
    v_mfma_f32_16x16x32_bf16 v[60:63], v[180:183], v[148:151], 0
    v_mfma_f32_16x16x32_bf16 v[64:67], v[180:183], v[152:155], 0
    v_mfma_f32_16x16x32_bf16 v[84:87], v[180:183], v[180:183], 0
    s_waitcnt lgkmcnt(0)
    s_waitcnt vmcnt(5)
    s_barrier
    s_nop 0
    v_add_u32 v119, 31104, v116
    v_add_u32 v120, 31104, v117
    v_add_u32 v121, 31104, v118
    v_mfma_f32_16x16x32_bf16 v[20:23], v[156:159], v[196:199], v[20:23]
    v_cndmask_b32 v192, v192, v10, s[62:63]
    ds_read_b128 v[184:187], v119 offset:2048
    s_add_u32 m0, s55, 74496
    v_mfma_f32_16x16x32_bf16 v[24:27], v[160:163], v[196:199], v[24:27]
    buffer_load_dwordx4 v111, s[24:27], s20 offen lds
    v_cndmask_b32 v193, v193, v10, s[62:63]
    v_mfma_f32_16x16x32_bf16 v[44:47], v[164:167], v[196:199], v[44:47]
    v_cndmask_b32 v194, v194, v10, s[62:63]
    ds_read_b128 v[188:191], v119 offset:4096
    v_mfma_f32_16x16x32_bf16 v[68:71], v[196:199], v[172:175], v[68:71]
    v_cndmask_b32 v195, v195, v10, s[62:63]
    s_add_u32 m0, s55, 78592
    v_mfma_f32_16x16x32_bf16 v[72:75], v[196:199], v[176:179], v[72:75]
    s_cmp_ge_u32 s48, 2
    s_cbranch_scc1 p1_skipx_8
    buffer_load_dwordx4 v112, s[24:27], s20 offen lds
p1_skipx_8:
    v_cndmask_b32 v168, v168, v10, s[68:69]
    ds_read_b128 v[180:183], v119 offset:0
    v_mfma_f32_16x16x32_bf16 v[88:91], v[196:199], v[196:199], v[88:91]
    v_cndmask_b32 v169, v169, v10, s[68:69]
    v_mfma_f32_16x16x32_bf16 v[28:31], v[156:159], v[200:203], v[28:31]
    v_cndmask_b32 v170, v170, v10, s[68:69]
    ds_read_b64_tr_b16 v[132:133], v121 offset:0
    v_mfma_f32_16x16x32_bf16 v[32:35], v[160:163], v[200:203], v[32:35]
    v_cndmask_b32 v171, v171, v10, s[68:69]
    s_add_u32 m0, s56, 70656
    v_mfma_f32_16x16x32_bf16 v[52:55], v[164:167], v[200:203], v[52:55]
    buffer_load_dwordx4 v115, s[28:31], s21 offen lds
    ds_read_b64_tr_b16 v[134:135], v121 offset:256
    v_mfma_f32_16x16x32_bf16 v[76:79], v[200:203], v[172:175], v[76:79]
    ds_read_b64_tr_b16 v[136:137], v121 offset:32
    ds_read_b64_tr_b16 v[138:139], v121 offset:288
    v_mfma_f32_16x16x32_bf16 v[80:83], v[200:203], v[176:179], v[80:83]
    ds_read_b64_tr_b16 v[140:141], v121 offset:4224
    v_mfma_f32_16x16x32_bf16 v[92:95], v[200:203], v[200:203], v[92:95]
    ds_read_b64_tr_b16 v[142:143], v121 offset:4480
    ds_read_b64_tr_b16 v[144:145], v121 offset:4256
    s_mov_b32 s22, 384
    s_mov_b32 s23, 516096
    s_add_u32 m0, s56, 93312
    v_mfma_f32_16x16x32_bf16 v[48:51], v[168:171], v[196:199], v[48:51]
    buffer_load_dwordx4 v113, s[28:31], s23 offen lds
    ds_read_b64_tr_b16 v[146:147], v121 offset:4512
    v_mfma_f32_16x16x32_bf16 v[56:59], v[168:171], v[200:203], v[56:59]
    ds_read_b64_tr_b16 v[148:149], v121 offset:8448
    ds_read_b64_tr_b16 v[150:151], v121 offset:8704
    v_mfma_f32_16x16x32_bf16 v[12:15], v[156:159], v[192:195], v[12:15]
    ds_read_b64_tr_b16 v[152:153], v121 offset:8480
    v_mfma_f32_16x16x32_bf16 v[16:19], v[160:163], v[192:195], v[16:19]
    ds_read_b64_tr_b16 v[154:155], v121 offset:8736
    s_add_u32 m0, s55, 93312
    v_mfma_f32_16x16x32_bf16 v[36:39], v[164:167], v[192:195], v[36:39]
    buffer_load_dwordx4 v108, s[24:27], s22 offen lds
    v_mfma_f32_16x16x32_bf16 v[40:43], v[168:171], v[192:195], v[40:43]
    v_mfma_f32_16x16x32_bf16 v[60:63], v[192:195], v[172:175], v[60:63]
    v_mfma_f32_16x16x32_bf16 v[64:67], v[192:195], v[176:179], v[64:67]
    v_mfma_f32_16x16x32_bf16 v[84:87], v[192:195], v[192:195], v[84:87]
    s_waitcnt lgkmcnt(0)
    s_nop 0
    v_mfma_f32_16x16x32_bf16 v[20:23], v[132:135], v[184:187], v[20:23]
    v_cndmask_b32 v180, v180, v10, s[62:63]
    ds_read_b128 v[196:199], v120 offset:2048
    s_add_u32 m0, s56, 97536
    v_mfma_f32_16x16x32_bf16 v[24:27], v[136:139], v[184:187], v[24:27]
    buffer_load_dwordx4 v114, s[28:31], s23 offen lds
    v_cndmask_b32 v181, v181, v10, s[62:63]
    v_mfma_f32_16x16x32_bf16 v[44:47], v[140:143], v[184:187], v[44:47]
    v_cndmask_b32 v182, v182, v10, s[62:63]
    ds_read_b128 v[200:203], v120 offset:4096
    v_mfma_f32_16x16x32_bf16 v[68:71], v[184:187], v[148:151], v[68:71]
    v_cndmask_b32 v183, v183, v10, s[62:63]
    s_add_u32 m0, s55, 97408
    v_mfma_f32_16x16x32_bf16 v[72:75], v[184:187], v[152:155], v[72:75]
    buffer_load_dwordx4 v109, s[24:27], s22 offen lds
    v_cndmask_b32 v144, v144, v10, s[68:69]
    ds_read_b128 v[192:195], v120 offset:0
    v_mfma_f32_16x16x32_bf16 v[88:91], v[184:187], v[184:187], v[88:91]
    v_cndmask_b32 v145, v145, v10, s[68:69]
    v_mfma_f32_16x16x32_bf16 v[28:31], v[132:135], v[188:191], v[28:31]
    v_cndmask_b32 v146, v146, v10, s[68:69]
    ds_read_b64_tr_b16 v[156:157], v121 offset:2112
    v_mfma_f32_16x16x32_bf16 v[32:35], v[136:139], v[188:191], v[32:35]
    v_cndmask_b32 v147, v147, v10, s[68:69]
    s_add_u32 m0, s55, 101504
    v_mfma_f32_16x16x32_bf16 v[52:55], v[140:143], v[188:191], v[52:55]
    buffer_load_dwordx4 v110, s[24:27], s22 offen lds
    ds_read_b64_tr_b16 v[158:159], v121 offset:2368
    v_mfma_f32_16x16x32_bf16 v[76:79], v[188:191], v[148:151], v[76:79]
    ds_read_b64_tr_b16 v[160:161], v121 offset:2144
    ds_read_b64_tr_b16 v[162:163], v121 offset:2400
    v_mfma_f32_16x16x32_bf16 v[80:83], v[188:191], v[152:155], v[80:83]
    ds_read_b64_tr_b16 v[164:165], v121 offset:6336
    v_mfma_f32_16x16x32_bf16 v[92:95], v[188:191], v[188:191], v[92:95]
    ds_read_b64_tr_b16 v[166:167], v121 offset:6592
    ds_read_b64_tr_b16 v[168:169], v121 offset:6368
    s_add_u32 m0, s55, 105600
    v_mfma_f32_16x16x32_bf16 v[48:51], v[144:147], v[184:187], v[48:51]
    buffer_load_dwordx4 v111, s[24:27], s22 offen lds
    ds_read_b64_tr_b16 v[170:171], v121 offset:6624
    v_mfma_f32_16x16x32_bf16 v[56:59], v[144:147], v[188:191], v[56:59]
    ds_read_b64_tr_b16 v[172:173], v121 offset:10560
    ds_read_b64_tr_b16 v[174:175], v121 offset:10816
    v_mfma_f32_16x16x32_bf16 v[12:15], v[132:135], v[180:183], v[12:15]
    ds_read_b64_tr_b16 v[176:177], v121 offset:10592
    v_mfma_f32_16x16x32_bf16 v[16:19], v[136:139], v[180:183], v[16:19]
    ds_read_b64_tr_b16 v[178:179], v121 offset:10848
    s_add_u32 m0, s55, 109696
    v_mfma_f32_16x16x32_bf16 v[36:39], v[140:143], v[180:183], v[36:39]
    s_cmp_ge_u32 s48, 2
    s_cbranch_scc1 p1_skipx_9
    buffer_load_dwordx4 v112, s[24:27], s22 offen lds
p1_skipx_9:
    v_mfma_f32_16x16x32_bf16 v[40:43], v[144:147], v[180:183], v[40:43]
    v_mfma_f32_16x16x32_bf16 v[60:63], v[180:183], v[148:151], v[60:63]
    v_mfma_f32_16x16x32_bf16 v[64:67], v[180:183], v[152:155], v[64:67]
    v_mfma_f32_16x16x32_bf16 v[84:87], v[180:183], v[180:183], v[84:87]
    s_waitcnt lgkmcnt(0)
    s_waitcnt vmcnt(6)
    s_barrier
    s_nop 0
    v_add_u32 v119, 62208, v116
    v_add_u32 v120, 62208, v117
    v_add_u32 v121, 62208, v118
    v_mfma_f32_16x16x32_bf16 v[20:23], v[156:159], v[196:199], v[20:23]
    v_cndmask_b32 v192, v192, v10, s[62:63]
    ds_read_b128 v[184:187], v119 offset:2048
    s_add_u32 m0, s56, 101760
    v_mfma_f32_16x16x32_bf16 v[24:27], v[160:163], v[196:199], v[24:27]
    buffer_load_dwordx4 v115, s[28:31], s23 offen lds
    v_cndmask_b32 v193, v193, v10, s[62:63]
    v_mfma_f32_16x16x32_bf16 v[44:47], v[164:167], v[196:199], v[44:47]
    v_cndmask_b32 v194, v194, v10, s[62:63]
    ds_read_b128 v[188:191], v119 offset:4096
    v_mfma_f32_16x16x32_bf16 v[68:71], v[196:199], v[172:175], v[68:71]
    v_cndmask_b32 v195, v195, v10, s[62:63]
    s_mov_b32 s20, 512
    s_mov_b32 s21, 688128
    s_add_u32 m0, s56, 124416
    v_mfma_f32_16x16x32_bf16 v[72:75], v[196:199], v[176:179], v[72:75]
    buffer_load_dwordx4 v113, s[28:31], s21 offen lds
    v_cndmask_b32 v168, v168, v10, s[68:69]
    ds_read_b128 v[180:183], v119 offset:0
    v_mfma_f32_16x16x32_bf16 v[88:91], v[196:199], v[196:199], v[88:91]
    v_cndmask_b32 v169, v169, v10, s[68:69]
    v_mfma_f32_16x16x32_bf16 v[28:31], v[156:159], v[200:203], v[28:31]
    v_cndmask_b32 v170, v170, v10, s[68:69]
    ds_read_b64_tr_b16 v[132:133], v121 offset:0
    v_mfma_f32_16x16x32_bf16 v[32:35], v[160:163], v[200:203], v[32:35]
    v_cndmask_b32 v171, v171, v10, s[68:69]
    s_add_u32 m0, s55, 124416
    v_mfma_f32_16x16x32_bf16 v[52:55], v[164:167], v[200:203], v[52:55]
    buffer_load_dwordx4 v108, s[24:27], s20 offen lds
    ds_read_b64_tr_b16 v[134:135], v121 offset:256
    v_mfma_f32_16x16x32_bf16 v[76:79], v[200:203], v[172:175], v[76:79]
    ds_read_b64_tr_b16 v[136:137], v121 offset:32
    ds_read_b64_tr_b16 v[138:139], v121 offset:288
    v_mfma_f32_16x16x32_bf16 v[80:83], v[200:203], v[176:179], v[80:83]
    ds_read_b64_tr_b16 v[140:141], v121 offset:4224
    v_mfma_f32_16x16x32_bf16 v[92:95], v[200:203], v[200:203], v[92:95]
    ds_read_b64_tr_b16 v[142:143], v121 offset:4480
    ds_read_b64_tr_b16 v[144:145], v121 offset:4256
    s_add_u32 m0, s56, 128640
    v_mfma_f32_16x16x32_bf16 v[48:51], v[168:171], v[196:199], v[48:51]
    buffer_load_dwordx4 v114, s[28:31], s21 offen lds
    ds_read_b64_tr_b16 v[146:147], v121 offset:4512
    v_mfma_f32_16x16x32_bf16 v[56:59], v[168:171], v[200:203], v[56:59]
    ds_read_b64_tr_b16 v[148:149], v121 offset:8448
    ds_read_b64_tr_b16 v[150:151], v121 offset:8704
    v_mfma_f32_16x16x32_bf16 v[12:15], v[156:159], v[192:195], v[12:15]
    ds_read_b64_tr_b16 v[152:153], v121 offset:8480
    v_mfma_f32_16x16x32_bf16 v[16:19], v[160:163], v[192:195], v[16:19]
    ds_read_b64_tr_b16 v[154:155], v121 offset:8736
    s_add_u32 m0, s55, 128512
    v_mfma_f32_16x16x32_bf16 v[36:39], v[164:167], v[192:195], v[36:39]
    buffer_load_dwordx4 v109, s[24:27], s20 offen lds
    v_mfma_f32_16x16x32_bf16 v[40:43], v[168:171], v[192:195], v[40:43]
    v_mfma_f32_16x16x32_bf16 v[60:63], v[192:195], v[172:175], v[60:63]
    v_mfma_f32_16x16x32_bf16 v[64:67], v[192:195], v[176:179], v[64:67]
    v_mfma_f32_16x16x32_bf16 v[84:87], v[192:195], v[192:195], v[84:87]
    s_waitcnt lgkmcnt(0)
    s_nop 0
    v_mfma_f32_16x16x32_bf16 v[20:23], v[132:135], v[184:187], v[20:23]
    v_cndmask_b32 v180, v180, v10, s[62:63]
    ds_read_b128 v[196:199], v120 offset:2048
    s_add_u32 m0, s55, 132608
    v_mfma_f32_16x16x32_bf16 v[24:27], v[136:139], v[184:187], v[24:27]
    buffer_load_dwordx4 v110, s[24:27], s20 offen lds
    v_cndmask_b32 v181, v181, v10, s[62:63]
    v_mfma_f32_16x16x32_bf16 v[44:47], v[140:143], v[184:187], v[44:47]
    v_cndmask_b32 v182, v182, v10, s[62:63]
    ds_read_b128 v[200:203], v120 offset:4096
    v_mfma_f32_16x16x32_bf16 v[68:71], v[184:187], v[148:151], v[68:71]
    v_cndmask_b32 v183, v183, v10, s[62:63]
    s_add_u32 m0, s55, 136704
    v_mfma_f32_16x16x32_bf16 v[72:75], v[184:187], v[152:155], v[72:75]
    buffer_load_dwordx4 v111, s[24:27], s20 offen lds
    v_cndmask_b32 v144, v144, v10, s[68:69]
    ds_read_b128 v[192:195], v120 offset:0
    v_mfma_f32_16x16x32_bf16 v[88:91], v[184:187], v[184:187], v[88:91]
    v_cndmask_b32 v145, v145, v10, s[68:69]
    v_mfma_f32_16x16x32_bf16 v[28:31], v[132:135], v[188:191], v[28:31]
    v_cndmask_b32 v146, v146, v10, s[68:69]
    ds_read_b64_tr_b16 v[156:157], v121 offset:2112
    v_mfma_f32_16x16x32_bf16 v[32:35], v[136:139], v[188:191], v[32:35]
    v_cndmask_b32 v147, v147, v10, s[68:69]
    s_add_u32 m0, s55, 140800
    v_mfma_f32_16x16x32_bf16 v[52:55], v[140:143], v[188:191], v[52:55]
    s_cmp_ge_u32 s48, 2
    s_cbranch_scc1 p1_skipx_10
    buffer_load_dwordx4 v112, s[24:27], s20 offen lds
p1_skipx_10:
    ds_read_b64_tr_b16 v[158:159], v121 offset:2368
    v_mfma_f32_16x16x32_bf16 v[76:79], v[188:191], v[148:151], v[76:79]
    ds_read_b64_tr_b16 v[160:161], v121 offset:2144
    ds_read_b64_tr_b16 v[162:163], v121 offset:2400
    v_mfma_f32_16x16x32_bf16 v[80:83], v[188:191], v[152:155], v[80:83]
    ds_read_b64_tr_b16 v[164:165], v121 offset:6336
    v_mfma_f32_16x16x32_bf16 v[92:95], v[188:191], v[188:191], v[92:95]
    ds_read_b64_tr_b16 v[166:167], v121 offset:6592
    ds_read_b64_tr_b16 v[168:169], v121 offset:6368
    s_add_u32 m0, s56, 132864
    v_mfma_f32_16x16x32_bf16 v[48:51], v[144:147], v[184:187], v[48:51]
    buffer_load_dwordx4 v115, s[28:31], s21 offen lds
    ds_read_b64_tr_b16 v[170:171], v121 offset:6624
    v_mfma_f32_16x16x32_bf16 v[56:59], v[144:147], v[188:191], v[56:59]
    ds_read_b64_tr_b16 v[172:173], v121 offset:10560
    ds_read_b64_tr_b16 v[174:175], v121 offset:10816
    v_mfma_f32_16x16x32_bf16 v[12:15], v[132:135], v[180:183], v[12:15]
    ds_read_b64_tr_b16 v[176:177], v121 offset:10592
    v_mfma_f32_16x16x32_bf16 v[16:19], v[136:139], v[180:183], v[16:19]
    ds_read_b64_tr_b16 v[178:179], v121 offset:10848
    s_mov_b32 s22, 640
    s_mov_b32 s23, 860160
    s_add_u32 m0, s56, 0
    s_nop 0
    v_mfma_f32_16x16x32_bf16 v[36:39], v[140:143], v[180:183], v[36:39]
    buffer_load_dwordx4 v113, s[28:31], s23 offen lds
    v_mfma_f32_16x16x32_bf16 v[40:43], v[144:147], v[180:183], v[40:43]
    v_mfma_f32_16x16x32_bf16 v[60:63], v[180:183], v[148:151], v[60:63]
    v_mfma_f32_16x16x32_bf16 v[64:67], v[180:183], v[152:155], v[64:67]
    v_mfma_f32_16x16x32_bf16 v[84:87], v[180:183], v[180:183], v[84:87]
    s_waitcnt lgkmcnt(0)
    s_waitcnt vmcnt(8)
    s_barrier
    s_nop 0
    v_add_u32 v119, 93312, v116
    v_add_u32 v120, 93312, v117
    v_add_u32 v121, 93312, v118
    v_mfma_f32_16x16x32_bf16 v[20:23], v[156:159], v[196:199], v[20:23]
    v_cndmask_b32 v192, v192, v10, s[62:63]
    ds_read_b128 v[184:187], v119 offset:2048
    s_add_u32 m0, s55, 0
    s_nop 0
    v_mfma_f32_16x16x32_bf16 v[24:27], v[160:163], v[196:199], v[24:27]
    buffer_load_dwordx4 v108, s[24:27], s22 offen lds
    v_cndmask_b32 v193, v193, v10, s[62:63]
    v_mfma_f32_16x16x32_bf16 v[44:47], v[164:167], v[196:199], v[44:47]
    v_cndmask_b32 v194, v194, v10, s[62:63]
    ds_read_b128 v[188:191], v119 offset:4096
    v_mfma_f32_16x16x32_bf16 v[68:71], v[196:199], v[172:175], v[68:71]
    v_cndmask_b32 v195, v195, v10, s[62:63]
    s_add_u32 m0, s56, 4224
    v_mfma_f32_16x16x32_bf16 v[72:75], v[196:199], v[176:179], v[72:75]
    buffer_load_dwordx4 v114, s[28:31], s23 offen lds
    v_cndmask_b32 v168, v168, v10, s[68:69]
    ds_read_b128 v[180:183], v119 offset:0
    v_mfma_f32_16x16x32_bf16 v[88:91], v[196:199], v[196:199], v[88:91]
    v_cndmask_b32 v169, v169, v10, s[68:69]
    v_mfma_f32_16x16x32_bf16 v[28:31], v[156:159], v[200:203], v[28:31]
    v_cndmask_b32 v170, v170, v10, s[68:69]
    ds_read_b64_tr_b16 v[132:133], v121 offset:0
    v_mfma_f32_16x16x32_bf16 v[32:35], v[160:163], v[200:203], v[32:35]
    v_cndmask_b32 v171, v171, v10, s[68:69]
    s_add_u32 m0, s55, 4096
    v_mfma_f32_16x16x32_bf16 v[52:55], v[164:167], v[200:203], v[52:55]
    buffer_load_dwordx4 v109, s[24:27], s22 offen lds
    ds_read_b64_tr_b16 v[134:135], v121 offset:256
    v_mfma_f32_16x16x32_bf16 v[76:79], v[200:203], v[172:175], v[76:79]
    ds_read_b64_tr_b16 v[136:137], v121 offset:32
    ds_read_b64_tr_b16 v[138:139], v121 offset:288
    v_mfma_f32_16x16x32_bf16 v[80:83], v[200:203], v[176:179], v[80:83]
    ds_read_b64_tr_b16 v[140:141], v121 offset:4224
    v_mfma_f32_16x16x32_bf16 v[92:95], v[200:203], v[200:203], v[92:95]
    ds_read_b64_tr_b16 v[142:143], v121 offset:4480
    ds_read_b64_tr_b16 v[144:145], v121 offset:4256
    s_add_u32 m0, s55, 8192
    v_mfma_f32_16x16x32_bf16 v[48:51], v[168:171], v[196:199], v[48:51]
    buffer_load_dwordx4 v110, s[24:27], s22 offen lds
    ds_read_b64_tr_b16 v[146:147], v121 offset:4512
    v_mfma_f32_16x16x32_bf16 v[56:59], v[168:171], v[200:203], v[56:59]
    ds_read_b64_tr_b16 v[148:149], v121 offset:8448
    ds_read_b64_tr_b16 v[150:151], v121 offset:8704
    v_mfma_f32_16x16x32_bf16 v[12:15], v[156:159], v[192:195], v[12:15]
    ds_read_b64_tr_b16 v[152:153], v121 offset:8480
    v_mfma_f32_16x16x32_bf16 v[16:19], v[160:163], v[192:195], v[16:19]
    ds_read_b64_tr_b16 v[154:155], v121 offset:8736
    s_add_u32 m0, s55, 12288
    v_mfma_f32_16x16x32_bf16 v[36:39], v[164:167], v[192:195], v[36:39]
    buffer_load_dwordx4 v111, s[24:27], s22 offen lds
    v_mfma_f32_16x16x32_bf16 v[40:43], v[168:171], v[192:195], v[40:43]
    v_mfma_f32_16x16x32_bf16 v[60:63], v[192:195], v[172:175], v[60:63]
    v_mfma_f32_16x16x32_bf16 v[64:67], v[192:195], v[176:179], v[64:67]
    v_mfma_f32_16x16x32_bf16 v[84:87], v[192:195], v[192:195], v[84:87]
    s_waitcnt lgkmcnt(0)
    v_mfma_f32_16x16x32_bf16 v[20:23], v[132:135], v[184:187], v[20:23]
    v_cndmask_b32 v180, v180, v10, s[62:63]
    ds_read_b128 v[196:199], v120 offset:2048
    s_add_u32 m0, s55, 16384
    v_mfma_f32_16x16x32_bf16 v[24:27], v[136:139], v[184:187], v[24:27]
    s_cmp_ge_u32 s48, 2
    s_cbranch_scc1 p1_skipx_11
    s_nop 0
    buffer_load_dwordx4 v112, s[24:27], s22 offen lds
p1_skipx_11:
    v_cndmask_b32 v181, v181, v10, s[62:63]
    v_mfma_f32_16x16x32_bf16 v[44:47], v[140:143], v[184:187], v[44:47]
    v_cndmask_b32 v182, v182, v10, s[62:63]
    ds_read_b128 v[200:203], v120 offset:4096
    v_mfma_f32_16x16x32_bf16 v[68:71], v[184:187], v[148:151], v[68:71]
    v_cndmask_b32 v183, v183, v10, s[62:63]
    s_add_u32 m0, s56, 8448
    v_mfma_f32_16x16x32_bf16 v[72:75], v[184:187], v[152:155], v[72:75]
    buffer_load_dwordx4 v115, s[28:31], s23 offen lds
    v_cndmask_b32 v144, v144, v10, s[68:69]
    ds_read_b128 v[192:195], v120 offset:0
    v_mfma_f32_16x16x32_bf16 v[88:91], v[184:187], v[184:187], v[88:91]
    v_cndmask_b32 v145, v145, v10, s[68:69]
    v_mfma_f32_16x16x32_bf16 v[28:31], v[132:135], v[188:191], v[28:31]
    v_cndmask_b32 v146, v146, v10, s[68:69]
    ds_read_b64_tr_b16 v[156:157], v121 offset:2112
    v_mfma_f32_16x16x32_bf16 v[32:35], v[136:139], v[188:191], v[32:35]
    v_cndmask_b32 v147, v147, v10, s[68:69]
    s_mov_b32 s20, 768
    s_mov_b32 s21, 1032192
    s_add_u32 m0, s56, 31104
    v_mfma_f32_16x16x32_bf16 v[52:55], v[140:143], v[188:191], v[52:55]
    buffer_load_dwordx4 v113, s[28:31], s21 offen lds
    ds_read_b64_tr_b16 v[158:159], v121 offset:2368
    v_mfma_f32_16x16x32_bf16 v[76:79], v[188:191], v[148:151], v[76:79]
    ds_read_b64_tr_b16 v[160:161], v121 offset:2144
    ds_read_b64_tr_b16 v[162:163], v121 offset:2400
    v_mfma_f32_16x16x32_bf16 v[80:83], v[188:191], v[152:155], v[80:83]
    ds_read_b64_tr_b16 v[164:165], v121 offset:6336
    v_mfma_f32_16x16x32_bf16 v[92:95], v[188:191], v[188:191], v[92:95]
    ds_read_b64_tr_b16 v[166:167], v121 offset:6592
    ds_read_b64_tr_b16 v[168:169], v121 offset:6368
    s_add_u32 m0, s55, 31104
    v_mfma_f32_16x16x32_bf16 v[48:51], v[144:147], v[184:187], v[48:51]
    buffer_load_dwordx4 v108, s[24:27], s20 offen lds
    ds_read_b64_tr_b16 v[170:171], v121 offset:6624
    v_mfma_f32_16x16x32_bf16 v[56:59], v[144:147], v[188:191], v[56:59]
    ds_read_b64_tr_b16 v[172:173], v121 offset:10560
    ds_read_b64_tr_b16 v[174:175], v121 offset:10816
    v_mfma_f32_16x16x32_bf16 v[12:15], v[132:135], v[180:183], v[12:15]
    ds_read_b64_tr_b16 v[176:177], v121 offset:10592
    v_mfma_f32_16x16x32_bf16 v[16:19], v[136:139], v[180:183], v[16:19]
    ds_read_b64_tr_b16 v[178:179], v121 offset:10848
    s_add_u32 m0, s56, 35328
    v_mfma_f32_16x16x32_bf16 v[36:39], v[140:143], v[180:183], v[36:39]
    buffer_load_dwordx4 v114, s[28:31], s21 offen lds
    v_mfma_f32_16x16x32_bf16 v[40:43], v[144:147], v[180:183], v[40:43]
    v_mfma_f32_16x16x32_bf16 v[60:63], v[180:183], v[148:151], v[60:63]
    v_mfma_f32_16x16x32_bf16 v[64:67], v[180:183], v[152:155], v[64:67]
    v_mfma_f32_16x16x32_bf16 v[84:87], v[180:183], v[180:183], v[84:87]
    s_waitcnt lgkmcnt(0)
    s_waitcnt vmcnt(10)
    s_barrier
    s_nop 0
    v_add_u32 v119, 124416, v116
    v_add_u32 v120, 124416, v117
    v_add_u32 v121, 124416, v118
    v_mfma_f32_16x16x32_bf16 v[20:23], v[156:159], v[196:199], v[20:23]
    v_cndmask_b32 v192, v192, v10, s[62:63]
    ds_read_b128 v[184:187], v119 offset:2048
    s_add_u32 m0, s55, 35200
    v_mfma_f32_16x16x32_bf16 v[24:27], v[160:163], v[196:199], v[24:27]
    buffer_load_dwordx4 v109, s[24:27], s20 offen lds
    v_cndmask_b32 v193, v193, v10, s[62:63]
    v_mfma_f32_16x16x32_bf16 v[44:47], v[164:167], v[196:199], v[44:47]
    v_cndmask_b32 v194, v194, v10, s[62:63]
    ds_read_b128 v[188:191], v119 offset:4096
    v_mfma_f32_16x16x32_bf16 v[68:71], v[196:199], v[172:175], v[68:71]
    v_cndmask_b32 v195, v195, v10, s[62:63]
    s_add_u32 m0, s55, 39296
    v_mfma_f32_16x16x32_bf16 v[72:75], v[196:199], v[176:179], v[72:75]
    buffer_load_dwordx4 v110, s[24:27], s20 offen lds
    v_cndmask_b32 v168, v168, v10, s[68:69]
    ds_read_b128 v[180:183], v119 offset:0
    v_mfma_f32_16x16x32_bf16 v[88:91], v[196:199], v[196:199], v[88:91]
    v_cndmask_b32 v169, v169, v10, s[68:69]
    v_mfma_f32_16x16x32_bf16 v[28:31], v[156:159], v[200:203], v[28:31]
    v_cndmask_b32 v170, v170, v10, s[68:69]
    ds_read_b64_tr_b16 v[132:133], v121 offset:0
    v_mfma_f32_16x16x32_bf16 v[32:35], v[160:163], v[200:203], v[32:35]
    v_cndmask_b32 v171, v171, v10, s[68:69]
    s_add_u32 m0, s55, 43392
    v_mfma_f32_16x16x32_bf16 v[52:55], v[164:167], v[200:203], v[52:55]
    buffer_load_dwordx4 v111, s[24:27], s20 offen lds
    ds_read_b64_tr_b16 v[134:135], v121 offset:256
    v_mfma_f32_16x16x32_bf16 v[76:79], v[200:203], v[172:175], v[76:79]
    ds_read_b64_tr_b16 v[136:137], v121 offset:32
    ds_read_b64_tr_b16 v[138:139], v121 offset:288
    v_mfma_f32_16x16x32_bf16 v[80:83], v[200:203], v[176:179], v[80:83]
    ds_read_b64_tr_b16 v[140:141], v121 offset:4224
    v_mfma_f32_16x16x32_bf16 v[92:95], v[200:203], v[200:203], v[92:95]
    ds_read_b64_tr_b16 v[142:143], v121 offset:4480
    ds_read_b64_tr_b16 v[144:145], v121 offset:4256
    s_add_u32 m0, s55, 47488
    v_mfma_f32_16x16x32_bf16 v[48:51], v[168:171], v[196:199], v[48:51]
    s_cmp_ge_u32 s48, 2
    s_cbranch_scc1 p1_skipx_12
    buffer_load_dwordx4 v112, s[24:27], s20 offen lds
p1_skipx_12:
    ds_read_b64_tr_b16 v[146:147], v121 offset:4512
    v_mfma_f32_16x16x32_bf16 v[56:59], v[168:171], v[200:203], v[56:59]
    ds_read_b64_tr_b16 v[148:149], v121 offset:8448
    ds_read_b64_tr_b16 v[150:151], v121 offset:8704
    v_mfma_f32_16x16x32_bf16 v[12:15], v[156:159], v[192:195], v[12:15]
    ds_read_b64_tr_b16 v[152:153], v121 offset:8480
    v_mfma_f32_16x16x32_bf16 v[16:19], v[160:163], v[192:195], v[16:19]
    ds_read_b64_tr_b16 v[154:155], v121 offset:8736
    s_add_u32 m0, s56, 39552
    v_mfma_f32_16x16x32_bf16 v[36:39], v[164:167], v[192:195], v[36:39]
    buffer_load_dwordx4 v115, s[28:31], s21 offen lds
    v_mfma_f32_16x16x32_bf16 v[40:43], v[168:171], v[192:195], v[40:43]
    v_mfma_f32_16x16x32_bf16 v[60:63], v[192:195], v[172:175], v[60:63]
    v_mfma_f32_16x16x32_bf16 v[64:67], v[192:195], v[176:179], v[64:67]
    v_mfma_f32_16x16x32_bf16 v[84:87], v[192:195], v[192:195], v[84:87]
    s_waitcnt lgkmcnt(0)
    s_add_u32 s20, s85, 0
    s_add_u32 s21, s85, 114688
    s_add_u32 s22, s85, 229376
    s_add_u32 s23, s85, 344064
    s_movk_i32 s98, 252
    s_nop 0
    buffer_load_dword v7, v5, s[44:47], s98 offen sc1
    v_mfma_f32_16x16x32_bf16 v[20:23], v[132:135], v[184:187], v[20:23]
    v_cndmask_b32 v180, v180, v10, s[62:63]
    ds_read_b128 v[196:199], v120 offset:2048
    v_mfma_f32_16x16x32_bf16 v[24:27], v[136:139], v[184:187], v[24:27]
    v_cndmask_b32 v181, v181, v10, s[62:63]
    v_mfma_f32_16x16x32_bf16 v[44:47], v[140:143], v[184:187], v[44:47]
    v_cndmask_b32 v182, v182, v10, s[62:63]
    ds_read_b128 v[200:203], v120 offset:4096
    v_mfma_f32_16x16x32_bf16 v[68:71], v[184:187], v[148:151], v[68:71]
    v_cndmask_b32 v183, v183, v10, s[62:63]
    v_mfma_f32_16x16x32_bf16 v[72:75], v[184:187], v[152:155], v[72:75]
    v_cndmask_b32 v144, v144, v10, s[68:69]
    ds_read_b128 v[192:195], v120 offset:0
    v_mfma_f32_16x16x32_bf16 v[88:91], v[184:187], v[184:187], v[88:91]
    v_cndmask_b32 v145, v145, v10, s[68:69]
    v_mfma_f32_16x16x32_bf16 v[28:31], v[132:135], v[188:191], v[28:31]
    v_cndmask_b32 v146, v146, v10, s[68:69]
    ds_read_b64_tr_b16 v[156:157], v121 offset:2112
    v_mfma_f32_16x16x32_bf16 v[32:35], v[136:139], v[188:191], v[32:35]
    v_cndmask_b32 v147, v147, v10, s[68:69]
    v_mfma_f32_16x16x32_bf16 v[52:55], v[140:143], v[188:191], v[52:55]
    ds_read_b64_tr_b16 v[158:159], v121 offset:2368
    v_mfma_f32_16x16x32_bf16 v[76:79], v[188:191], v[148:151], v[76:79]
    ds_read_b64_tr_b16 v[160:161], v121 offset:2144
    ds_read_b64_tr_b16 v[162:163], v121 offset:2400
    v_mfma_f32_16x16x32_bf16 v[80:83], v[188:191], v[152:155], v[80:83]
    ds_read_b64_tr_b16 v[164:165], v121 offset:6336
    v_mfma_f32_16x16x32_bf16 v[92:95], v[188:191], v[188:191], v[92:95]
    ds_read_b64_tr_b16 v[166:167], v121 offset:6592
    ds_read_b64_tr_b16 v[168:169], v121 offset:6368
    v_mfma_f32_16x16x32_bf16 v[48:51], v[144:147], v[184:187], v[48:51]
    ds_read_b64_tr_b16 v[170:171], v121 offset:6624
    v_mfma_f32_16x16x32_bf16 v[56:59], v[144:147], v[188:191], v[56:59]
    ds_read_b64_tr_b16 v[172:173], v121 offset:10560
    ds_read_b64_tr_b16 v[174:175], v121 offset:10816
    v_mfma_f32_16x16x32_bf16 v[12:15], v[132:135], v[180:183], v[12:15]
    ds_read_b64_tr_b16 v[176:177], v121 offset:10592
    v_mfma_f32_16x16x32_bf16 v[16:19], v[136:139], v[180:183], v[16:19]
    ds_read_b64_tr_b16 v[178:179], v121 offset:10848
    v_mfma_f32_16x16x32_bf16 v[36:39], v[140:143], v[180:183], v[36:39]
    v_mfma_f32_16x16x32_bf16 v[40:43], v[144:147], v[180:183], v[40:43]
    v_mfma_f32_16x16x32_bf16 v[60:63], v[180:183], v[148:151], v[60:63]
    v_mfma_f32_16x16x32_bf16 v[64:67], v[180:183], v[152:155], v[64:67]
    v_mfma_f32_16x16x32_bf16 v[84:87], v[180:183], v[180:183], v[84:87]
    s_waitcnt lgkmcnt(0)
    s_waitcnt vmcnt(8)
    s_barrier
    v_add_u32 v119, 0, v116
    v_add_u32 v120, 0, v117
    v_add_u32 v121, 0, v118
    v_mfma_f32_16x16x32_bf16 v[20:23], v[156:159], v[196:199], v[20:23]
    v_cndmask_b32 v192, v192, v10, s[62:63]
    ds_read_b128 v[184:187], v119 offset:2048
    s_add_u32 m0, s99, 0
    s_nop 0
    v_mfma_f32_16x16x32_bf16 v[24:27], v[160:163], v[196:199], v[24:27]
    buffer_load_dwordx4 v122, s[4:7], s20 offen lds
    v_cndmask_b32 v193, v193, v10, s[62:63]
    v_mfma_f32_16x16x32_bf16 v[44:47], v[164:167], v[196:199], v[44:47]
    v_cndmask_b32 v194, v194, v10, s[62:63]
    ds_read_b128 v[188:191], v119 offset:4096
    s_add_u32 m0, s99, 4096
    v_mfma_f32_16x16x32_bf16 v[68:71], v[196:199], v[172:175], v[68:71]
    buffer_load_dwordx4 v123, s[4:7], s20 offen lds
    v_cndmask_b32 v195, v195, v10, s[62:63]
    v_mfma_f32_16x16x32_bf16 v[72:75], v[196:199], v[176:179], v[72:75]
    v_cndmask_b32 v168, v168, v10, s[68:69]
    ds_read_b128 v[180:183], v119 offset:0
    v_mfma_f32_16x16x32_bf16 v[88:91], v[196:199], v[196:199], v[88:91]
    v_cndmask_b32 v169, v169, v10, s[68:69]
    s_add_u32 m0, s99, 8192
    v_mfma_f32_16x16x32_bf16 v[28:31], v[156:159], v[200:203], v[28:31]
    buffer_load_dwordx4 v124, s[4:7], s20 offen lds
    v_cndmask_b32 v170, v170, v10, s[68:69]
    ds_read_b64_tr_b16 v[132:133], v121 offset:0
    v_mfma_f32_16x16x32_bf16 v[32:35], v[160:163], v[200:203], v[32:35]
    v_cndmask_b32 v171, v171, v10, s[68:69]
    v_mfma_f32_16x16x32_bf16 v[52:55], v[164:167], v[200:203], v[52:55]
    ds_read_b64_tr_b16 v[134:135], v121 offset:256
    s_add_u32 m0, s99, 12288
    v_mfma_f32_16x16x32_bf16 v[76:79], v[200:203], v[172:175], v[76:79]
    buffer_load_dwordx4 v125, s[4:7], s20 offen lds
    ds_read_b64_tr_b16 v[136:137], v121 offset:32
    ds_read_b64_tr_b16 v[138:139], v121 offset:288
    v_mfma_f32_16x16x32_bf16 v[80:83], v[200:203], v[176:179], v[80:83]
    ds_read_b64_tr_b16 v[140:141], v121 offset:4224
    s_add_u32 m0, s99, 16384
    v_mfma_f32_16x16x32_bf16 v[92:95], v[200:203], v[200:203], v[92:95]
    buffer_load_dwordx4 v126, s[4:7], s20 offen lds
    ds_read_b64_tr_b16 v[142:143], v121 offset:4480
    ds_read_b64_tr_b16 v[144:145], v121 offset:4256
    v_mfma_f32_16x16x32_bf16 v[48:51], v[168:171], v[196:199], v[48:51]
    ds_read_b64_tr_b16 v[146:147], v121 offset:4512
    v_mfma_f32_16x16x32_bf16 v[56:59], v[168:171], v[200:203], v[56:59]
    ds_read_b64_tr_b16 v[148:149], v121 offset:8448
    ds_read_b64_tr_b16 v[150:151], v121 offset:8704
    s_add_u32 m0, s99, 20480
    v_mfma_f32_16x16x32_bf16 v[12:15], v[156:159], v[192:195], v[12:15]
    buffer_load_dwordx4 v127, s[4:7], s20 offen lds
    ds_read_b64_tr_b16 v[152:153], v121 offset:8480
    v_mfma_f32_16x16x32_bf16 v[16:19], v[160:163], v[192:195], v[16:19]
    ds_read_b64_tr_b16 v[154:155], v121 offset:8736
    v_mfma_f32_16x16x32_bf16 v[36:39], v[164:167], v[192:195], v[36:39]
    s_add_u32 m0, s99, 24576
    v_mfma_f32_16x16x32_bf16 v[40:43], v[168:171], v[192:195], v[40:43]
    buffer_load_dwordx4 v128, s[4:7], s20 offen lds
    v_mfma_f32_16x16x32_bf16 v[60:63], v[192:195], v[172:175], v[60:63]
    v_mfma_f32_16x16x32_bf16 v[64:67], v[192:195], v[176:179], v[64:67]
    v_mfma_f32_16x16x32_bf16 v[84:87], v[192:195], v[192:195], v[84:87]
    s_waitcnt lgkmcnt(0)
    s_nop 0
    v_mfma_f32_16x16x32_bf16 v[20:23], v[132:135], v[184:187], v[20:23]
    v_cndmask_b32 v180, v180, v10, s[62:63]
    ds_read_b128 v[196:199], v120 offset:2048
    s_add_u32 m0, s99, 28672
    v_mfma_f32_16x16x32_bf16 v[24:27], v[136:139], v[184:187], v[24:27]
    buffer_load_dwordx4 v122, s[4:7], s21 offen lds
    v_cndmask_b32 v181, v181, v10, s[62:63]
    v_mfma_f32_16x16x32_bf16 v[44:47], v[140:143], v[184:187], v[44:47]
    v_cndmask_b32 v182, v182, v10, s[62:63]
    ds_read_b128 v[200:203], v120 offset:4096
    s_add_u32 m0, s99, 32768
    v_mfma_f32_16x16x32_bf16 v[68:71], v[184:187], v[148:151], v[68:71]
    buffer_load_dwordx4 v123, s[4:7], s21 offen lds
    v_cndmask_b32 v183, v183, v10, s[62:63]
    v_mfma_f32_16x16x32_bf16 v[72:75], v[184:187], v[152:155], v[72:75]
    v_cndmask_b32 v144, v144, v10, s[68:69]
    ds_read_b128 v[192:195], v120 offset:0
    v_mfma_f32_16x16x32_bf16 v[88:91], v[184:187], v[184:187], v[88:91]
    v_cndmask_b32 v145, v145, v10, s[68:69]
    s_add_u32 m0, s99, 36864
    v_mfma_f32_16x16x32_bf16 v[28:31], v[132:135], v[188:191], v[28:31]
    buffer_load_dwordx4 v124, s[4:7], s21 offen lds
    v_cndmask_b32 v146, v146, v10, s[68:69]
    ds_read_b64_tr_b16 v[156:157], v121 offset:2112
    v_mfma_f32_16x16x32_bf16 v[32:35], v[136:139], v[188:191], v[32:35]
    v_cndmask_b32 v147, v147, v10, s[68:69]
    v_mfma_f32_16x16x32_bf16 v[52:55], v[140:143], v[188:191], v[52:55]
    ds_read_b64_tr_b16 v[158:159], v121 offset:2368
    s_add_u32 m0, s99, 40960
    v_mfma_f32_16x16x32_bf16 v[76:79], v[188:191], v[148:151], v[76:79]
    buffer_load_dwordx4 v125, s[4:7], s21 offen lds
    ds_read_b64_tr_b16 v[160:161], v121 offset:2144
    ds_read_b64_tr_b16 v[162:163], v121 offset:2400
    v_mfma_f32_16x16x32_bf16 v[80:83], v[188:191], v[152:155], v[80:83]
    ds_read_b64_tr_b16 v[164:165], v121 offset:6336
    s_add_u32 m0, s99, 45056
    v_mfma_f32_16x16x32_bf16 v[92:95], v[188:191], v[188:191], v[92:95]
    buffer_load_dwordx4 v126, s[4:7], s21 offen lds
    ds_read_b64_tr_b16 v[166:167], v121 offset:6592
    ds_read_b64_tr_b16 v[168:169], v121 offset:6368
    v_mfma_f32_16x16x32_bf16 v[48:51], v[144:147], v[184:187], v[48:51]
    ds_read_b64_tr_b16 v[170:171], v121 offset:6624
    v_mfma_f32_16x16x32_bf16 v[56:59], v[144:147], v[188:191], v[56:59]
    ds_read_b64_tr_b16 v[172:173], v121 offset:10560
    ds_read_b64_tr_b16 v[174:175], v121 offset:10816
    s_add_u32 m0, s99, 49152
    v_mfma_f32_16x16x32_bf16 v[12:15], v[132:135], v[180:183], v[12:15]
    buffer_load_dwordx4 v127, s[4:7], s21 offen lds
    ds_read_b64_tr_b16 v[176:177], v121 offset:10592
    v_mfma_f32_16x16x32_bf16 v[16:19], v[136:139], v[180:183], v[16:19]
    ds_read_b64_tr_b16 v[178:179], v121 offset:10848
    v_mfma_f32_16x16x32_bf16 v[36:39], v[140:143], v[180:183], v[36:39]
    s_add_u32 m0, s99, 53248
    v_mfma_f32_16x16x32_bf16 v[40:43], v[144:147], v[180:183], v[40:43]
    buffer_load_dwordx4 v128, s[4:7], s21 offen lds
    v_mfma_f32_16x16x32_bf16 v[60:63], v[180:183], v[148:151], v[60:63]
    v_mfma_f32_16x16x32_bf16 v[64:67], v[180:183], v[152:155], v[64:67]
    v_mfma_f32_16x16x32_bf16 v[84:87], v[180:183], v[180:183], v[84:87]
    s_waitcnt lgkmcnt(0)
    s_waitcnt vmcnt(15)
    s_barrier
    s_nop 0
    v_add_u32 v119, 31104, v116
    v_add_u32 v120, 31104, v117
    v_add_u32 v121, 31104, v118
    v_mfma_f32_16x16x32_bf16 v[20:23], v[156:159], v[196:199], v[20:23]
    v_cndmask_b32 v192, v192, v10, s[62:63]
    ds_read_b128 v[184:187], v119 offset:2048
    s_add_u32 m0, s99, 57344
    v_mfma_f32_16x16x32_bf16 v[24:27], v[160:163], v[196:199], v[24:27]
    buffer_load_dwordx4 v122, s[4:7], s22 offen lds
    v_cndmask_b32 v193, v193, v10, s[62:63]
    v_mfma_f32_16x16x32_bf16 v[44:47], v[164:167], v[196:199], v[44:47]
    v_cndmask_b32 v194, v194, v10, s[62:63]
    ds_read_b128 v[188:191], v119 offset:4096
    s_add_u32 m0, s99, 61440
    v_mfma_f32_16x16x32_bf16 v[68:71], v[196:199], v[172:175], v[68:71]
    buffer_load_dwordx4 v123, s[4:7], s22 offen lds
    v_cndmask_b32 v195, v195, v10, s[62:63]
    v_mfma_f32_16x16x32_bf16 v[72:75], v[196:199], v[176:179], v[72:75]
    v_cndmask_b32 v168, v168, v10, s[68:69]
    ds_read_b128 v[180:183], v119 offset:0
    v_mfma_f32_16x16x32_bf16 v[88:91], v[196:199], v[196:199], v[88:91]
    v_cndmask_b32 v169, v169, v10, s[68:69]
    s_add_u32 m0, s99, 65536
    v_mfma_f32_16x16x32_bf16 v[28:31], v[156:159], v[200:203], v[28:31]
    buffer_load_dwordx4 v124, s[4:7], s22 offen lds
    v_cndmask_b32 v170, v170, v10, s[68:69]
    ds_read_b64_tr_b16 v[132:133], v121 offset:0
    v_mfma_f32_16x16x32_bf16 v[32:35], v[160:163], v[200:203], v[32:35]
    v_cndmask_b32 v171, v171, v10, s[68:69]
    v_mfma_f32_16x16x32_bf16 v[52:55], v[164:167], v[200:203], v[52:55]
    ds_read_b64_tr_b16 v[134:135], v121 offset:256
    s_add_u32 m0, s99, 69632
    v_mfma_f32_16x16x32_bf16 v[76:79], v[200:203], v[172:175], v[76:79]
    buffer_load_dwordx4 v125, s[4:7], s22 offen lds
    ds_read_b64_tr_b16 v[136:137], v121 offset:32
    ds_read_b64_tr_b16 v[138:139], v121 offset:288
    v_mfma_f32_16x16x32_bf16 v[80:83], v[200:203], v[176:179], v[80:83]
    ds_read_b64_tr_b16 v[140:141], v121 offset:4224
    s_add_u32 m0, s99, 73728
    v_mfma_f32_16x16x32_bf16 v[92:95], v[200:203], v[200:203], v[92:95]
    buffer_load_dwordx4 v126, s[4:7], s22 offen lds
    ds_read_b64_tr_b16 v[142:143], v121 offset:4480
    ds_read_b64_tr_b16 v[144:145], v121 offset:4256
    v_mfma_f32_16x16x32_bf16 v[48:51], v[168:171], v[196:199], v[48:51]
    ds_read_b64_tr_b16 v[146:147], v121 offset:4512
    v_mfma_f32_16x16x32_bf16 v[56:59], v[168:171], v[200:203], v[56:59]
    ds_read_b64_tr_b16 v[148:149], v121 offset:8448
    ds_read_b64_tr_b16 v[150:151], v121 offset:8704
    s_add_u32 m0, s99, 77824
    v_mfma_f32_16x16x32_bf16 v[12:15], v[156:159], v[192:195], v[12:15]
    buffer_load_dwordx4 v127, s[4:7], s22 offen lds
    ds_read_b64_tr_b16 v[152:153], v121 offset:8480
    v_mfma_f32_16x16x32_bf16 v[16:19], v[160:163], v[192:195], v[16:19]
    ds_read_b64_tr_b16 v[154:155], v121 offset:8736
    v_mfma_f32_16x16x32_bf16 v[36:39], v[164:167], v[192:195], v[36:39]
    s_add_u32 m0, s99, 81920
    v_mfma_f32_16x16x32_bf16 v[40:43], v[168:171], v[192:195], v[40:43]
    buffer_load_dwordx4 v128, s[4:7], s22 offen lds
    v_mfma_f32_16x16x32_bf16 v[60:63], v[192:195], v[172:175], v[60:63]
    v_mfma_f32_16x16x32_bf16 v[64:67], v[192:195], v[176:179], v[64:67]
    v_mfma_f32_16x16x32_bf16 v[84:87], v[192:195], v[192:195], v[84:87]
    s_waitcnt lgkmcnt(0)
    s_nop 0
    v_mfma_f32_16x16x32_bf16 v[20:23], v[132:135], v[184:187], v[20:23]
    v_cndmask_b32 v180, v180, v10, s[62:63]
    ds_read_b128 v[196:199], v120 offset:2048
    s_add_u32 m0, s99, 86016
    v_mfma_f32_16x16x32_bf16 v[24:27], v[136:139], v[184:187], v[24:27]
    buffer_load_dwordx4 v122, s[4:7], s23 offen lds
    v_cndmask_b32 v181, v181, v10, s[62:63]
    v_mfma_f32_16x16x32_bf16 v[44:47], v[140:143], v[184:187], v[44:47]
    v_cndmask_b32 v182, v182, v10, s[62:63]
    ds_read_b128 v[200:203], v120 offset:4096
    v_mfma_f32_16x16x32_bf16 v[68:71], v[184:187], v[148:151], v[68:71]
    v_cndmask_b32 v183, v183, v10, s[62:63]
    v_mfma_f32_16x16x32_bf16 v[72:75], v[184:187], v[152:155], v[72:75]
    v_cndmask_b32 v144, v144, v10, s[68:69]
    ds_read_b128 v[192:195], v120 offset:0
    s_add_u32 m0, s99, 90112
    v_mfma_f32_16x16x32_bf16 v[88:91], v[184:187], v[184:187], v[88:91]
    buffer_load_dwordx4 v123, s[4:7], s23 offen lds
    v_cndmask_b32 v145, v145, v10, s[68:69]
    v_mfma_f32_16x16x32_bf16 v[28:31], v[132:135], v[188:191], v[28:31]
    v_cndmask_b32 v146, v146, v10, s[68:69]
    ds_read_b64_tr_b16 v[156:157], v121 offset:2112
    v_mfma_f32_16x16x32_bf16 v[32:35], v[136:139], v[188:191], v[32:35]
    v_cndmask_b32 v147, v147, v10, s[68:69]
    v_mfma_f32_16x16x32_bf16 v[52:55], v[140:143], v[188:191], v[52:55]
    ds_read_b64_tr_b16 v[158:159], v121 offset:2368
    v_mfma_f32_16x16x32_bf16 v[76:79], v[188:191], v[148:151], v[76:79]
    ds_read_b64_tr_b16 v[160:161], v121 offset:2144
    ds_read_b64_tr_b16 v[162:163], v121 offset:2400
    s_add_u32 m0, s99, 94208
    v_mfma_f32_16x16x32_bf16 v[80:83], v[188:191], v[152:155], v[80:83]
    buffer_load_dwordx4 v124, s[4:7], s23 offen lds
    ds_read_b64_tr_b16 v[164:165], v121 offset:6336
    v_mfma_f32_16x16x32_bf16 v[92:95], v[188:191], v[188:191], v[92:95]
    ds_read_b64_tr_b16 v[166:167], v121 offset:6592
    ds_read_b64_tr_b16 v[168:169], v121 offset:6368
    v_mfma_f32_16x16x32_bf16 v[48:51], v[144:147], v[184:187], v[48:51]
    ds_read_b64_tr_b16 v[170:171], v121 offset:6624
    v_mfma_f32_16x16x32_bf16 v[56:59], v[144:147], v[188:191], v[56:59]
    ds_read_b64_tr_b16 v[172:173], v121 offset:10560
    ds_read_b64_tr_b16 v[174:175], v121 offset:10816
    v_mfma_f32_16x16x32_bf16 v[12:15], v[132:135], v[180:183], v[12:15]
    ds_read_b64_tr_b16 v[176:177], v121 offset:10592
    s_add_u32 m0, s99, 98304
    v_mfma_f32_16x16x32_bf16 v[16:19], v[136:139], v[180:183], v[16:19]
    s_cmp_ge_u32 s48, 2
    s_cbranch_scc1 wo_skip_7
    buffer_load_dwordx4 v125, s[4:7], s23 offen lds
wo_skip_7:
    ds_read_b64_tr_b16 v[178:179], v121 offset:10848
    v_mfma_f32_16x16x32_bf16 v[36:39], v[140:143], v[180:183], v[36:39]
    v_mfma_f32_16x16x32_bf16 v[40:43], v[144:147], v[180:183], v[40:43]
    v_mfma_f32_16x16x32_bf16 v[60:63], v[180:183], v[148:151], v[60:63]
    v_mfma_f32_16x16x32_bf16 v[64:67], v[180:183], v[152:155], v[64:67]
    v_mfma_f32_16x16x32_bf16 v[84:87], v[180:183], v[180:183], v[84:87]
    s_waitcnt lgkmcnt(0)
    s_nop 0
    v_mfma_f32_16x16x32_bf16 v[20:23], v[156:159], v[196:199], v[20:23]
    v_cndmask_b32 v192, v192, v10, s[62:63]
    v_mfma_f32_16x16x32_bf16 v[24:27], v[160:163], v[196:199], v[24:27]
    v_cndmask_b32 v193, v193, v10, s[62:63]
    v_mfma_f32_16x16x32_bf16 v[44:47], v[164:167], v[196:199], v[44:47]
    v_cndmask_b32 v194, v194, v10, s[62:63]
    v_mfma_f32_16x16x32_bf16 v[68:71], v[196:199], v[172:175], v[68:71]
    v_cndmask_b32 v195, v195, v10, s[62:63]
    v_mfma_f32_16x16x32_bf16 v[72:75], v[196:199], v[176:179], v[72:75]
    v_cndmask_b32 v168, v168, v10, s[68:69]
    v_mfma_f32_16x16x32_bf16 v[88:91], v[196:199], v[196:199], v[88:91]
    v_cndmask_b32 v169, v169, v10, s[68:69]
    v_mfma_f32_16x16x32_bf16 v[28:31], v[156:159], v[200:203], v[28:31]
    v_cndmask_b32 v170, v170, v10, s[68:69]
    v_mfma_f32_16x16x32_bf16 v[32:35], v[160:163], v[200:203], v[32:35]
    v_cndmask_b32 v171, v171, v10, s[68:69]
    v_mfma_f32_16x16x32_bf16 v[52:55], v[164:167], v[200:203], v[52:55]
    v_mfma_f32_16x16x32_bf16 v[76:79], v[200:203], v[172:175], v[76:79]
    v_mfma_f32_16x16x32_bf16 v[80:83], v[200:203], v[176:179], v[80:83]
    v_mfma_f32_16x16x32_bf16 v[92:95], v[200:203], v[200:203], v[92:95]
    v_mfma_f32_16x16x32_bf16 v[48:51], v[168:171], v[196:199], v[48:51]
    v_mfma_f32_16x16x32_bf16 v[56:59], v[168:171], v[200:203], v[56:59]
    v_mfma_f32_16x16x32_bf16 v[12:15], v[156:159], v[192:195], v[12:15]
    v_mfma_f32_16x16x32_bf16 v[16:19], v[160:163], v[192:195], v[16:19]
    v_mfma_f32_16x16x32_bf16 v[36:39], v[164:167], v[192:195], v[36:39]
    v_mfma_f32_16x16x32_bf16 v[40:43], v[168:171], v[192:195], v[40:43]
    v_mfma_f32_16x16x32_bf16 v[60:63], v[192:195], v[172:175], v[60:63]
    v_mfma_f32_16x16x32_bf16 v[64:67], v[192:195], v[176:179], v[64:67]
    v_mfma_f32_16x16x32_bf16 v[84:87], v[192:195], v[192:195], v[84:87]
    s_barrier
    s_cmp_ge_u32 s100, 224
    s_cbranch_scc1 p0_iss_done_14
    v_lshrrev_b32_e64 v108, 3, v0
    s_cmp_ge_u32 s100, 112
    s_cbranch_scc1 p0_b_13
    s_lshr_b32 s58, s100, 2
    s_and_b32 s59, s100, 3
    s_lshr_b32 s49, s48, 1
    s_cmp_eq_u32 s49, 0
    s_cselect_b32 s36, s12, s14
    s_cselect_b32 s37, s13, s15
    s_and_b32 s37, s37, 0xffff
    s_mov_b32 s38, 1605632
    s_mov_b32 s39, 0x20000
    v_mul_u32_u24 v109, 3584, v108
    v_and_b32 v108, 7, v0
    v_lshl_add_u32 v109, v108, 4, v109
    s_mul_i32 s50, s59, 401408
    s_lshl_b32 s51, s58, 7
    s_add_u32 s50, s50, s51
    s_and_b32 s51, s48, 1
    s_mul_i32 s52, s51, 28672
    s_add_u32 s50, s50, s52
    s_mul_i32 s49, s49, 14336
    s_lshl_b32 s51, s51, 10
    s_add_u32 s49, s49, s51
    s_add_u32 m0, s49, 0
    s_nop 0
    buffer_load_dwordx4 v109, s[36:39], s50 offen lds
    s_add_u32 m0, s49, 2048
    s_add_u32 s50, s50, 57344
    buffer_load_dwordx4 v109, s[36:39], s50 offen lds
    s_add_u32 m0, s49, 4096
    s_add_u32 s50, s50, 57344
    buffer_load_dwordx4 v109, s[36:39], s50 offen lds
    s_add_u32 m0, s49, 6144
    s_add_u32 s50, s50, 57344
    buffer_load_dwordx4 v109, s[36:39], s50 offen lds
    s_add_u32 m0, s49, 8192
    s_add_u32 s50, s50, 57344
    buffer_load_dwordx4 v109, s[36:39], s50 offen lds
    s_add_u32 m0, s49, 10240
    s_add_u32 s50, s50, 57344
    buffer_load_dwordx4 v109, s[36:39], s50 offen lds
    s_add_u32 m0, s49, 12288
    s_add_u32 s50, s50, 57344
    buffer_load_dwordx4 v109, s[36:39], s50 offen lds
    s_branch p0_iss_done_14
p0_b_13:
    s_mov_b32 s36, s16
    s_and_b32 s37, s17, 0xffff
    s_mov_b32 s38, 1605632
    s_mov_b32 s39, 0x20000
    s_sub_u32 s49, s100, 112
    s_mul_i32 s59, s49, 9363
    s_lshr_b32 s59, s59, 16
    s_mul_i32 s50, s59, 7
    s_sub_u32 s58, s49, s50
    v_mul_u32_u24 v109, 896, v108
    v_and_b32 v108, 7, v0
    v_lshl_add_u32 v109, v108, 4, v109
    s_mul_i32 s50, s59, 100352
    s_lshl_b32 s51, s58, 7
    s_add_u32 s50, s50, s51
    s_mul_i32 s52, s48, 7168
    s_add_u32 s50, s50, s52
    s_lshl_b32 s49, s48, 10
    s_add_u32 m0, s49, 0
    s_nop 0
    buffer_load_dwordx4 v109, s[36:39], s50 offen lds
    s_add_u32 m0, s49, 4096
    s_add_u32 s50, s50, 28672
    buffer_load_dwordx4 v109, s[36:39], s50 offen lds
    s_add_u32 m0, s49, 8192
    s_add_u32 s50, s50, 28672
    buffer_load_dwordx4 v109, s[36:39], s50 offen lds
    s_cmp_ge_u32 s48, 2
    s_cbranch_scc1 p0_iss_done_14
    s_add_u32 m0, s49, 12288
    s_add_u32 s50, s50, 28672
    buffer_load_dwordx4 v109, s[36:39], s50 offen lds
p0_iss_done_14:
    s_nop 1
    s_nop 0
    s_mov_b32 s78, 0x3b124925
    s_mov_b32 s79, 0x3727c5ac
    s_mov_b32 s80, 0x3e8b97f6
    v_cndmask_b32 v125, 0, v84, s[70:71]
    v_cndmask_b32 v126, 0, v88, s[70:71]
    v_cndmask_b32 v127, 0, v92, s[70:71]
    v_cndmask_b32 v125, v125, v85, s[72:73]
    v_cndmask_b32 v126, v126, v89, s[72:73]
    v_cndmask_b32 v127, v127, v93, s[72:73]
    v_cndmask_b32 v125, v125, v86, s[74:75]
    v_cndmask_b32 v126, v126, v90, s[74:75]
    v_cndmask_b32 v127, v127, v94, s[74:75]
    v_cndmask_b32 v125, v125, v87, s[76:77]
    v_cndmask_b32 v126, v126, v91, s[76:77]
    v_cndmask_b32 v127, v127, v95, s[76:77]
    v_mov_b32 v122, v40
    v_mov_b32 v128, v40
    v_mov_b32 v123, v48
    v_mov_b32 v129, v48
    v_mov_b32 v124, v56
    v_mov_b32 v130, v56
    v_permlane32_swap_b32 v122, v128
    v_permlane32_swap_b32 v123, v129
    v_permlane32_swap_b32 v124, v130
    v_mov_b32 v122, v128
    v_mov_b32 v123, v129
    v_mov_b32 v124, v130
    v_permlane16_swap_b32 v128, v122
    v_permlane16_swap_b32 v129, v123
    v_permlane16_swap_b32 v130, v124
    v_mov_b32 v128, v125
    v_mov_b32 v129, v126
    v_mov_b32 v130, v127
    v_permlane16_swap_b32 v125, v128
    v_permlane16_swap_b32 v126, v129
    v_permlane16_swap_b32 v127, v130
    v_add_f32 v125, v125, v128
    v_add_f32 v126, v126, v129
    v_add_f32 v127, v127, v130
    v_mov_b32 v128, v125
    v_mov_b32 v129, v126
    v_mov_b32 v130, v127
    v_permlane32_swap_b32 v125, v128
    v_permlane32_swap_b32 v126, v129
    v_permlane32_swap_b32 v127, v130
    v_add_f32 v125, v125, v128
    v_add_f32 v126, v126, v129
    v_add_f32 v127, v127, v130
    v_mul_f32 v110, s78, v122
    v_mul_f32 v128, s78, v125
    v_mul_f32 v112, s78, v123
    v_mul_f32 v129, s78, v126
    v_mul_f32 v114, s78, v124
    v_mul_f32_e64 v130, s78, v127
    v_fma_f32 v128, -v110, v110, v128
    v_fma_f32 v129, -v112, v112, v129
    v_fma_f32 v130, -v114, v114, v130
    v_max_f32 v128, 0, v128
    v_max_f32 v129, 0, v129
    v_max_f32 v130, 0, v130
    v_add_f32 v128, s79, v128
    v_add_f32 v129, s79, v129
    v_add_f32 v130, s79, v130
    v_rsq_f32 v116, v128
    v_sub_f32 v110, 0, v110
    v_rsq_f32 v118, v129
    v_sub_f32 v112, 0, v112
    v_rsq_f32 v120, v130
    v_sub_f32 v114, 0, v114
    s_mul_i32 s49, s48, 384
    s_add_u32 s49, s49, 57344
    v_and_b32 v131, 15, v0
    v_lshlrev_b32 v131, 2, v131
    v_add_u32 v131, s49, v131
    v_lshrrev_b32 v132, 4, v0
    v_lshlrev_b32 v132, 4, v132
    v_add_u32 v132, s49, v132
    ds_write_b32 v131, v110 offset:0
    ds_write_b32 v131, v116 offset:64
    ds_write_b32 v131, v112 offset:128
    ds_write_b32 v131, v118 offset:192
    ds_write_b32 v131, v114 offset:256
    ds_write_b32 v131, v120 offset:320
    s_waitcnt lgkmcnt(0)
    s_nop 0
    ds_read_b128 v[136:139], v132 offset:0
    ds_read_b128 v[148:151], v132 offset:64
    ds_read_b128 v[140:143], v132 offset:128
    ds_read_b128 v[152:155], v132 offset:192
    ds_read_b128 v[144:147], v132 offset:256
    ds_read_b128 v[156:159], v132 offset:320
    v_mov_b32_dpp v160, v12 row_newbcast:0 row_mask:0xf bank_mask:0xf
    v_mov_b32_dpp v168, v36 row_newbcast:0 row_mask:0xf bank_mask:0xf
    v_mov_b32_dpp v161, v13 row_newbcast:0 row_mask:0xf bank_mask:0xf
    v_mov_b32_dpp v169, v37 row_newbcast:0 row_mask:0xf bank_mask:0xf
    v_mov_b32_dpp v162, v14 row_newbcast:0 row_mask:0xf bank_mask:0xf
    v_mov_b32_dpp v170, v38 row_newbcast:0 row_mask:0xf bank_mask:0xf
    v_mov_b32_dpp v163, v15 row_newbcast:0 row_mask:0xf bank_mask:0xf
    v_mov_b32_dpp v171, v39 row_newbcast:0 row_mask:0xf bank_mask:0xf
    v_mov_b32_dpp v164, v16 row_newbcast:0 row_mask:0xf bank_mask:0xf
    v_mov_b32_dpp v172, v40 row_newbcast:0 row_mask:0xf bank_mask:0xf
    v_mov_b32_dpp v165, v17 row_newbcast:0 row_mask:0xf bank_mask:0xf
    v_mov_b32_dpp v173, v41 row_newbcast:0 row_mask:0xf bank_mask:0xf
    v_mov_b32_dpp v166, v18 row_newbcast:0 row_mask:0xf bank_mask:0xf
    v_mov_b32_dpp v174, v42 row_newbcast:0 row_mask:0xf bank_mask:0xf
    v_mov_b32_dpp v167, v19 row_newbcast:0 row_mask:0xf bank_mask:0xf
    v_mov_b32_dpp v175, v43 row_newbcast:0 row_mask:0xf bank_mask:0xf
    v_mov_b32 v176, v60
    v_mov_b32 v177, v60
    v_mov_b32 v178, v64
    v_mov_b32 v179, v64
    v_permlane16_swap_b32 v176, v177
    s_nop 0
    v_permlane16_swap_b32 v178, v179
    v_mov_b32 v177, v176
    v_mov_b32 v179, v178
    s_nop 0
    v_permlane32_swap_b32 v176, v177
    v_permlane32_swap_b32 v178, v179
    v_mul_f32 v180, s80, v118
    v_mul_f32 v182, s80, v120
    v_cndmask_b32 v184, 0, v180, s[64:65]
    v_cndmask_b32 v186, 0, v182, s[64:65]
    v_pk_fma_f32 v[220:221], v[160:161], v[112:113], v[20:21] op_sel_hi:[1,0,1]
    v_pk_fma_f32 v[222:223], v[162:163], v[112:113], v[22:23] op_sel_hi:[1,0,1]
    v_pk_fma_f32 v[224:225], v[164:165], v[112:113], v[24:25] op_sel_hi:[1,0,1]
    v_pk_fma_f32 v[226:227], v[166:167], v[112:113], v[26:27] op_sel_hi:[1,0,1]
    v_pk_mul_f32 v[220:221], v[220:221], v[180:181] op_sel_hi:[1,0]
    v_pk_mul_f32 v[222:223], v[222:223], v[180:181] op_sel_hi:[1,0]
    v_pk_mul_f32 v[224:225], v[224:225], v[184:185] op_sel_hi:[1,0]
    v_pk_mul_f32 v[226:227], v[226:227], v[184:185] op_sel_hi:[1,0]
    v_cvt_pk_bf16_f32 v188, v220, v221
    v_cvt_pk_bf16_f32 v189, v222, v223
    v_cvt_pk_bf16_f32 v190, v224, v225
    v_cvt_pk_bf16_f32 v191, v226, v227
    v_pk_fma_f32 v[220:221], v[160:161], v[114:115], v[28:29] op_sel_hi:[1,0,1]
    v_pk_fma_f32 v[222:223], v[162:163], v[114:115], v[30:31] op_sel_hi:[1,0,1]
    v_pk_fma_f32 v[224:225], v[164:165], v[114:115], v[32:33] op_sel_hi:[1,0,1]
    v_pk_fma_f32 v[226:227], v[166:167], v[114:115], v[34:35] op_sel_hi:[1,0,1]
    v_pk_mul_f32 v[220:221], v[220:221], v[182:183] op_sel_hi:[1,0]
    v_pk_mul_f32 v[222:223], v[222:223], v[182:183] op_sel_hi:[1,0]
    v_pk_mul_f32 v[224:225], v[224:225], v[186:187] op_sel_hi:[1,0]
    v_pk_mul_f32 v[226:227], v[226:227], v[186:187] op_sel_hi:[1,0]
    v_cvt_pk_bf16_f32 v192, v220, v221
    v_cvt_pk_bf16_f32 v193, v222, v223
    v_cvt_pk_bf16_f32 v194, v224, v225
    v_cvt_pk_bf16_f32 v195, v226, v227
    v_pk_fma_f32 v[220:221], v[168:169], v[110:111], v[36:37] op_sel_hi:[1,0,1]
    v_pk_fma_f32 v[222:223], v[170:171], v[110:111], v[38:39] op_sel_hi:[1,0,1]
    v_pk_fma_f32 v[224:225], v[172:173], v[110:111], v[40:41] op_sel_hi:[1,0,1]
    v_pk_fma_f32 v[226:227], v[174:175], v[110:111], v[42:43] op_sel_hi:[1,0,1]
    v_pk_mul_f32 v[220:221], v[220:221], v[116:117] op_sel_hi:[1,0]
    v_pk_mul_f32 v[222:223], v[222:223], v[116:117] op_sel_hi:[1,0]
    v_pk_mul_f32 v[224:225], v[224:225], v[116:117] op_sel_hi:[1,0]
    v_pk_mul_f32 v[226:227], v[226:227], v[116:117] op_sel_hi:[1,0]
    v_cvt_pk_bf16_f32 v196, v220, v221
    v_cvt_pk_bf16_f32 v197, v222, v223
    v_cvt_pk_bf16_f32 v198, v224, v225
    v_cvt_pk_bf16_f32 v199, v226, v227
    v_pk_fma_f32 v[220:221], v[168:169], v[112:113], v[44:45] op_sel_hi:[1,0,1]
    v_pk_fma_f32 v[222:223], v[170:171], v[112:113], v[46:47] op_sel_hi:[1,0,1]
    v_pk_fma_f32 v[224:225], v[172:173], v[112:113], v[48:49] op_sel_hi:[1,0,1]
    v_pk_fma_f32 v[226:227], v[174:175], v[112:113], v[50:51] op_sel_hi:[1,0,1]
    v_pk_mul_f32 v[220:221], v[220:221], v[118:119] op_sel_hi:[1,0]
    v_pk_mul_f32 v[222:223], v[222:223], v[118:119] op_sel_hi:[1,0]
    v_pk_mul_f32 v[224:225], v[224:225], v[118:119] op_sel_hi:[1,0]
    v_pk_mul_f32 v[226:227], v[226:227], v[118:119] op_sel_hi:[1,0]
    v_cvt_pk_bf16_f32 v200, v220, v221
    v_cvt_pk_bf16_f32 v201, v222, v223
    v_cvt_pk_bf16_f32 v202, v224, v225
    v_cvt_pk_bf16_f32 v203, v226, v227
    v_pk_fma_f32 v[220:221], v[168:169], v[114:115], v[52:53] op_sel_hi:[1,0,1]
    v_pk_fma_f32 v[222:223], v[170:171], v[114:115], v[54:55] op_sel_hi:[1,0,1]
    v_pk_fma_f32 v[224:225], v[172:173], v[114:115], v[56:57] op_sel_hi:[1,0,1]
    v_pk_fma_f32 v[226:227], v[174:175], v[114:115], v[58:59] op_sel_hi:[1,0,1]
    v_pk_mul_f32 v[220:221], v[220:221], v[120:121] op_sel_hi:[1,0]
    v_pk_mul_f32 v[222:223], v[222:223], v[120:121] op_sel_hi:[1,0]
    v_pk_mul_f32 v[224:225], v[224:225], v[120:121] op_sel_hi:[1,0]
    v_pk_mul_f32 v[226:227], v[226:227], v[120:121] op_sel_hi:[1,0]
    v_cvt_pk_bf16_f32 v204, v220, v221
    v_cvt_pk_bf16_f32 v205, v222, v223
    v_cvt_pk_bf16_f32 v206, v224, v225
    v_cvt_pk_bf16_f32 v207, v226, v227
    v_mfma_f32_16x16x32_bf16 v[20:23], v[196:199], v[188:191], 0
    v_mfma_f32_16x16x32_bf16 v[24:27], v[200:203], v[188:191], 0
    v_mfma_f32_16x16x32_bf16 v[28:31], v[200:203], v[192:195], 0
    v_mfma_f32_16x16x32_bf16 v[32:35], v[204:207], v[192:195], 0
    s_waitcnt lgkmcnt(5)
    v_pk_fma_f32 v[220:221], v[136:137], v[176:177], v[60:61] op_sel_hi:[1,0,1]
    v_pk_fma_f32 v[222:223], v[138:139], v[176:177], v[62:63] op_sel_hi:[1,0,1]
    v_pk_fma_f32 v[224:225], v[136:137], v[178:179], v[64:65] op_sel_hi:[1,0,1]
    v_pk_fma_f32 v[226:227], v[138:139], v[178:179], v[66:67] op_sel_hi:[1,0,1]
    s_waitcnt lgkmcnt(4)
    v_pk_mul_f32 v[220:221], v[220:221], v[148:149]
    v_pk_mul_f32 v[222:223], v[222:223], v[150:151]
    v_pk_mul_f32 v[224:225], v[224:225], v[148:149]
    v_pk_mul_f32 v[226:227], v[226:227], v[150:151]
    v_cvt_pk_bf16_f32 v208, v220, v221
    v_cvt_pk_bf16_f32 v209, v222, v223
    v_cvt_pk_bf16_f32 v214, v224, v225
    v_cvt_pk_bf16_f32 v215, v226, v227
    s_waitcnt lgkmcnt(3)
    v_pk_fma_f32 v[220:221], v[140:141], v[176:177], v[68:69] op_sel_hi:[1,0,1]
    v_pk_fma_f32 v[222:223], v[142:143], v[176:177], v[70:71] op_sel_hi:[1,0,1]
    v_pk_fma_f32 v[224:225], v[140:141], v[178:179], v[72:73] op_sel_hi:[1,0,1]
    v_pk_fma_f32 v[226:227], v[142:143], v[178:179], v[74:75] op_sel_hi:[1,0,1]
    s_waitcnt lgkmcnt(2)
    v_pk_mul_f32 v[220:221], v[220:221], v[152:153]
    v_pk_mul_f32 v[222:223], v[222:223], v[154:155]
    v_pk_mul_f32 v[224:225], v[224:225], v[152:153]
    v_pk_mul_f32 v[226:227], v[226:227], v[154:155]
    v_cvt_pk_bf16_f32 v210, v220, v221
    v_cvt_pk_bf16_f32 v211, v222, v223
    v_cvt_pk_bf16_f32 v216, v224, v225
    v_cvt_pk_bf16_f32 v217, v226, v227
    s_waitcnt lgkmcnt(1)
    v_pk_fma_f32 v[220:221], v[144:145], v[176:177], v[76:77] op_sel_hi:[1,0,1]
    v_pk_fma_f32 v[222:223], v[146:147], v[176:177], v[78:79] op_sel_hi:[1,0,1]
    v_pk_fma_f32 v[224:225], v[144:145], v[178:179], v[80:81] op_sel_hi:[1,0,1]
    v_pk_fma_f32 v[226:227], v[146:147], v[178:179], v[82:83] op_sel_hi:[1,0,1]
    s_waitcnt lgkmcnt(0)
    v_pk_mul_f32 v[220:221], v[220:221], v[156:157]
    v_pk_mul_f32 v[222:223], v[222:223], v[158:159]
    v_pk_mul_f32 v[224:225], v[224:225], v[156:157]
    v_pk_mul_f32 v[226:227], v[226:227], v[158:159]
    v_cvt_pk_bf16_f32 v212, v220, v221
    v_cvt_pk_bf16_f32 v213, v222, v223
    v_cvt_pk_bf16_f32 v218, v224, v225
    v_cvt_pk_bf16_f32 v219, v226, v227
    v_pk_add_f32 v[20:21], v[20:21], v[104:105]
    v_pk_add_f32 v[24:25], v[24:25], v[100:101]
    v_pk_add_f32 v[22:23], v[22:23], v[106:107]
    v_pk_add_f32 v[26:27], v[26:27], v[102:103]
    v_pk_add_f32 v[28:29], v[28:29], v[96:97]
    v_pk_add_f32 v[32:33], v[32:33], v[100:101]
    v_pk_add_f32 v[30:31], v[30:31], v[98:99]
    v_pk_add_f32 v[34:35], v[34:35], v[102:103]
    v_max3_f32 v228, v20, v21, v22
    v_max3_f32 v229, v28, v29, v30
    v_max3_f32 v228, v228, v23, v24
    v_max3_f32 v229, v229, v31, v32
    v_max3_f32 v228, v228, v25, v26
    v_max3_f32 v229, v229, v33, v34
    v_max_f32 v228, v228, v27
    v_max_f32 v229, v229, v35
    v_mov_b32 v108, v228
    v_mov_b32 v109, v229
    s_nop 0
    v_permlane16_swap_b32 v228, v108
    v_permlane16_swap_b32 v229, v109
    v_max_f32 v228, v228, v108
    v_max_f32 v229, v229, v109
    v_mov_b32 v108, v228
    v_mov_b32 v109, v229
    s_nop 0
    v_permlane32_swap_b32 v228, v108
    v_permlane32_swap_b32 v229, v109
    v_max_f32 v228, v228, v108
    v_max_f32 v229, v229, v109
    v_sub_f32 v20, v20, v228
    v_sub_f32 v21, v21, v228
    v_sub_f32 v22, v22, v228
    v_sub_f32 v23, v23, v228
    v_sub_f32 v24, v24, v228
    v_sub_f32 v25, v25, v228
    v_sub_f32 v26, v26, v228
    v_sub_f32 v27, v27, v228
    v_sub_f32 v28, v28, v229
    v_sub_f32 v29, v29, v229
    v_sub_f32 v30, v30, v229
    v_sub_f32 v31, v31, v229
    v_sub_f32 v32, v32, v229
    v_sub_f32 v33, v33, v229
    v_sub_f32 v34, v34, v229
    v_sub_f32 v35, v35, v229
    v_exp_f32 v20, v20
    v_exp_f32 v21, v21
    v_exp_f32 v22, v22
    v_exp_f32 v23, v23
    v_exp_f32 v24, v24
    v_exp_f32 v25, v25
    v_exp_f32 v26, v26
    v_exp_f32 v27, v27
    v_exp_f32 v28, v28
    v_exp_f32 v29, v29
    v_exp_f32 v30, v30
    v_exp_f32 v31, v31
    v_exp_f32 v32, v32
    v_exp_f32 v33, v33
    v_exp_f32 v34, v34
    v_exp_f32 v35, v35
    v_cvt_pk_bf16_f32 v12, v20, v21
    v_cvt_pk_bf16_f32 v13, v22, v23
    v_cvt_pk_bf16_f32 v14, v24, v25
    v_cvt_pk_bf16_f32 v15, v26, v27
    v_cvt_pk_bf16_f32 v16, v28, v29
    v_cvt_pk_bf16_f32 v17, v30, v31
    v_cvt_pk_bf16_f32 v18, v32, v33
    v_cvt_pk_bf16_f32 v19, v34, v35
    v_mfma_f32_16x16x32_bf16 v[44:47], v[208:211], v[12:15], 0
    v_mfma_f32_16x16x32_bf16 v[48:51], v[214:217], v[12:15], 0
    v_mfma_f32_16x16x32_bf16 v[52:55], v[210:213], v[16:19], 0
    v_mfma_f32_16x16x32_bf16 v[56:59], v[216:219], v[16:19], 0
    v_add_f32 v20, v20, v21
    v_add_f32 v22, v22, v23
    v_add_f32 v24, v24, v25
    v_add_f32 v26, v26, v27
    v_add_f32 v28, v28, v29
    v_add_f32 v30, v30, v31
    v_add_f32 v32, v32, v33
    v_add_f32 v34, v34, v35
    v_add_f32 v20, v20, v22
    v_add_f32 v24, v24, v26
    v_add_f32 v28, v28, v30
    v_add_f32 v32, v32, v34
    v_add_f32 v230, v20, v24
    v_add_f32 v232, v28, v32
    v_mov_b32 v108, v230
    v_mov_b32 v109, v232
    s_nop 0
    v_permlane16_swap_b32 v230, v108
    v_permlane16_swap_b32 v232, v109
    v_add_f32 v230, v230, v108
    v_add_f32 v232, v232, v109
    v_mov_b32 v108, v230
    v_mov_b32 v109, v232
    s_nop 0
    v_permlane32_swap_b32 v230, v108
    v_permlane32_swap_b32 v232, v109
    v_add_f32 v230, v230, v108
    v_add_f32 v232, v232, v109
    v_rcp_f32 v230, v230
    v_rcp_f32 v232, v232
    v_cndmask_b32 v234, 0, v230, s[64:65]
    v_cndmask_b32 v236, 0, v232, s[64:65]
    v_lshlrev_b32_e64 v238, 4, v0
    s_lshl_b32 s49, s53, 3
    s_lshl_b32 s50, s48, 1
    s_add_u32 s49, s49, s50
    s_lshl_b32 s49, s49, 4
    s_add_u32 s49, s49, s54
    s_lshl_b32 s49, s49, 10
    s_add_u32 s49, s49, 5373952
    v_pk_mul_f32 v[44:45], v[44:45], v[230:231] op_sel_hi:[1,0]
    v_pk_mul_f32 v[46:47], v[46:47], v[230:231] op_sel_hi:[1,0]
    v_pk_mul_f32 v[48:49], v[48:49], v[234:235] op_sel_hi:[1,0]
    v_pk_mul_f32 v[50:51], v[50:51], v[234:235] op_sel_hi:[1,0]
    v_cvt_pk_bf16_f32 v12, v44, v45
    v_cvt_pk_bf16_f32 v13, v46, v47
    v_cvt_pk_bf16_f32 v14, v48, v49
    v_cvt_pk_bf16_f32 v15, v50, v51
    buffer_store_dwordx4 v[12:15], v238, s[32:35], s49 offen sc1
    v_pk_mul_f32 v[52:53], v[52:53], v[232:233] op_sel_hi:[1,0]
    v_pk_mul_f32 v[54:55], v[54:55], v[232:233] op_sel_hi:[1,0]
    v_pk_mul_f32 v[56:57], v[56:57], v[236:237] op_sel_hi:[1,0]
    v_pk_mul_f32 v[58:59], v[58:59], v[236:237] op_sel_hi:[1,0]
    v_cvt_pk_bf16_f32 v16, v52, v53
    v_cvt_pk_bf16_f32 v17, v54, v55
    v_cvt_pk_bf16_f32 v18, v56, v57
    v_cvt_pk_bf16_f32 v19, v58, v59
    s_add_u32 s49, s49, 16384
    buffer_store_dwordx4 v[16:19], v238, s[32:35], s49 offen sc1
    s_cmp_ge_u32 s100, 224
    s_cbranch_scc1 p0sc_n_16
    s_cmp_ge_u32 s100, 112
    s_cbranch_scc1 p0sc_b_15
    s_lshl_b32 s49, s58, 2
    s_add_u32 s49, s49, s48
    s_mul_i32 s50, s49, 28
    s_mul_i32 s51, s59, 7
    s_add_u32 s50, s50, s51
    s_lshl_b32 s50, s50, 10
    s_add_u32 s8, s50, 458752
    s_add_u32 s9, s8, 1024
    s_add_u32 s10, s8, 2048
    s_add_u32 s11, s8, 3072
    s_add_u32 s12, s8, 4096
    s_add_u32 s13, s8, 5120
    s_add_u32 s14, s8, 6144
    s_mul_i32 s50, s59, 112
    s_add_u32 s50, s50, s49
    s_lshl_b32 s50, s50, 7
    s_add_u32 s15, s50, 5275648
    s_branch p0sc_done_17
p0sc_b_15:
    s_lshr_b32 s49, s59, 2
    s_lshl_b32 s50, s58, 2
    s_add_u32 s49, s49, s50
    s_mul_i32 s49, s49, 56
    s_lshr_b32 s50, s48, 1
    s_lshl_b32 s50, s50, 2
    s_and_b32 s51, s59, 3
    s_add_u32 s50, s50, s51
    s_lshl_b32 s50, s50, 1
    s_and_b32 s51, s48, 1
    s_add_u32 s50, s50, s51
    s_add_u32 s49, s49, s50
    s_lshl_b32 s49, s49, 10
    s_add_u32 s8, s49, 3670016
    s_add_u32 s9, s8, 16384
    s_add_u32 s10, s8, 32768
    s_add_u32 s11, s8, 49152
    s_cmp_ge_u32 s48, 2
    s_cmov_b32 s11, 1073741824
    s_mov_b32 s12, 1073741824
    s_mov_b32 s13, 1073741824
    s_mov_b32 s14, 1073741824
    s_mov_b32 s15, 1073741824
    s_branch p0sc_done_17
p0sc_n_16:
    s_mov_b32 s8, 1073741824
    s_mov_b32 s9, 1073741824
    s_mov_b32 s10, 1073741824
    s_mov_b32 s11, 1073741824
    s_mov_b32 s12, 1073741824
    s_mov_b32 s13, 1073741824
    s_mov_b32 s14, 1073741824
    s_mov_b32 s15, 1073741824
p0sc_done_17:
    s_mov_b32 s52, 0x01010101
    s_waitcnt vmcnt(26)
    v_cmp_ne_u32 vcc, s52, v7
    s_nop 0
    s_cmp_eq_u64 vcc, 0
    s_cbranch_scc1 polld_19
    s_mov_b32 s61, 0
poll_18:
    buffer_load_dword v7, v5, s[44:47], s98 offen sc1
    s_waitcnt vmcnt(0)
    v_cmp_ne_u32 vcc, s52, v7
    s_add_u32 s61, s61, 1
    s_cmp_gt_u32 s61, 32768
    s_cbranch_scc1 polld_19
    s_cmp_eq_u64 vcc, 0
    s_cbranch_scc1 polld_19
    s_sleep 2
    s_branch poll_18
polld_19:
    s_waitcnt vmcnt(0)
    s_barrier
    s_cmp_lg_u32 s48, 3
    s_cbranch_scc1 sig_20
    s_mov_b64 exec, 1
    buffer_atomic_add v4, v5, s[32:35], s88 offen sc1
    s_mov_b64 exec, -1
sig_20:
    s_cmp_ge_u32 s100, 112
    s_cbranch_scc1 p0p_b_21
    v_bfe_u32 v11, v0, 4, 1
    v_mul_u32_u24 v12, 14336, v11
    v_lshrrev_b32_e64 v11, 5, v0
    v_lshl_add_u32 v12, v11, 10, v12
    v_bfe_u32 v11, v0, 2, 2
    v_lshl_add_u32 v12, v11, 7, v12
    v_and_b32_e64 v11, 3, v0
    v_lshl_add_u32 v12, v11, 3, v12
    s_lshl_b32 s49, s48, 5
    s_add_u32 s49, s49, 0
    v_add_u32_e64 v12, s49, v12
    ds_read_b64_tr_b16 v[16:17], v12 offset:0
    ds_read_b64_tr_b16 v[18:19], v12 offset:512
    ds_read_b64_tr_b16 v[20:21], v12 offset:2048
    ds_read_b64_tr_b16 v[22:23], v12 offset:2560
    ds_read_b64_tr_b16 v[24:25], v12 offset:4096
    ds_read_b64_tr_b16 v[26:27], v12 offset:4608
    ds_read_b64_tr_b16 v[28:29], v12 offset:6144
    ds_read_b64_tr_b16 v[30:31], v12 offset:6656
    ds_read_b64_tr_b16 v[32:33], v12 offset:8192
    ds_read_b64_tr_b16 v[34:35], v12 offset:8704
    ds_read_b64_tr_b16 v[36:37], v12 offset:10240
    ds_read_b64_tr_b16 v[38:39], v12 offset:10752
    ds_read_b64_tr_b16 v[40:41], v12 offset:12288
    ds_read_b64_tr_b16 v[42:43], v12 offset:12800
    s_branch p0p_done_22
p0p_b_21:
    v_bfe_u32 v11, v0, 4, 1
    v_lshlrev_b32 v12, 5, v11
    v_lshrrev_b32_e64 v11, 5, v0
    v_lshl_add_u32 v12, v11, 9, v12
    v_bfe_u32 v11, v0, 2, 2
    v_lshl_add_u32 v12, v11, 7, v12
    v_and_b32_e64 v11, 3, v0
    v_lshl_add_u32 v12, v11, 3, v12
    s_and_b32 s49, s48, 1
    s_lshr_b32 s50, s48, 1
    s_lshl_b32 s51, s49, 6
    s_lshl_b32 s52, s50, 11
    s_add_u32 s51, s51, s52
    s_add_u32 s51, s51, 0
    v_add_u32 v12, s51, v12
    s_waitcnt lgkmcnt(0)
    ds_read_b64_tr_b16 v[16:17], v12 offset:0
    ds_read_b64_tr_b16 v[18:19], v12 offset:1024
    ds_read_b64_tr_b16 v[20:21], v12 offset:4096
    ds_read_b64_tr_b16 v[22:23], v12 offset:5120
    ds_read_b64_tr_b16 v[24:25], v12 offset:8192
    ds_read_b64_tr_b16 v[26:27], v12 offset:9216
    ds_read_b64_tr_b16 v[28:29], v12 offset:12288
    ds_read_b64_tr_b16 v[30:31], v12 offset:13312
p0p_done_22:
    s_waitcnt lgkmcnt(0)
    s_nop 0
    buffer_store_dwordx4 v[16:19], v6, s[32:35], s8 offen sc1
    buffer_store_dwordx4 v[20:23], v6, s[32:35], s9 offen sc1
    buffer_store_dwordx4 v[24:27], v6, s[32:35], s10 offen sc1
    buffer_store_dwordx4 v[28:31], v6, s[32:35], s11 offen sc1
    buffer_store_dwordx4 v[32:35], v6, s[32:35], s12 offen sc1
    buffer_store_dwordx4 v[36:39], v6, s[32:35], s13 offen sc1
    buffer_store_dwordx4 v[40:43], v6, s[32:35], s14 offen sc1
    v_mov_b32 v13, 0
    v_mov_b32 v11, 0
    v_dot2_f32_bf16 v13, v16, v10, v13
    v_dot2_f32_bf16 v11, v17, v10, v11
    v_dot2_f32_bf16 v13, v18, v10, v13
    v_dot2_f32_bf16 v11, v19, v10, v11
    v_dot2_f32_bf16 v13, v20, v10, v13
    v_dot2_f32_bf16 v11, v21, v10, v11
    v_dot2_f32_bf16 v13, v22, v10, v13
    v_dot2_f32_bf16 v11, v23, v10, v11
    v_dot2_f32_bf16 v13, v24, v10, v13
    v_dot2_f32_bf16 v11, v25, v10, v11
    v_dot2_f32_bf16 v13, v26, v10, v13
    v_dot2_f32_bf16 v11, v27, v10, v11
    v_dot2_f32_bf16 v13, v28, v10, v13
    v_dot2_f32_bf16 v11, v29, v10, v11
    v_dot2_f32_bf16 v13, v30, v10, v13
    v_dot2_f32_bf16 v11, v31, v10, v11
    v_dot2_f32_bf16 v13, v32, v10, v13
    v_dot2_f32_bf16 v11, v33, v10, v11
    v_dot2_f32_bf16 v13, v34, v10, v13
    v_dot2_f32_bf16 v11, v35, v10, v11
    v_dot2_f32_bf16 v13, v36, v10, v13
    v_dot2_f32_bf16 v11, v37, v10, v11
    v_dot2_f32_bf16 v13, v38, v10, v13
    v_dot2_f32_bf16 v11, v39, v10, v11
    v_dot2_f32_bf16 v13, v40, v10, v13
    v_dot2_f32_bf16 v11, v41, v10, v11
    v_dot2_f32_bf16 v13, v42, v10, v13
    v_dot2_f32_bf16 v11, v43, v10, v11
    s_nop 2
    v_add_f32 v13, v13, v11
    v_mov_b32 v11, v13
    s_nop 1
    v_permlane32_swap_b32 v13, v11
    v_add_f32 v13, v13, v11
    v_and_b32 v11, 31, v0
    v_lshlrev_b32 v11, 2, v11
    buffer_store_dword v13, v11, s[32:35], s15 offen sc1
    v_and_b32 v11, 15, v0
    s_lshl_b32 s51, s90, 4
    v_add_u32_e64 v11, s51, v11
    v_mul_u32_u24 v13, 896, v11
    v_lshrrev_b32_e64 v12, 4, v0
    v_lshl_add_u32 v13, v12, 3, v13
    s_lshl_b32 s51, s91, 7
    v_add_u32 v13, s51, v13
    s_mul_i32 s51, s92, 28672
    s_mul_i32 s52, s93, 224
    s_add_u32 s51, s51, s52
    buffer_load_dwordx2 v[100:101], v13, s[24:27], s51 offen offset:0
    buffer_load_dwordx2 v[102:103], v13, s[24:27], s51 offen offset:32
    buffer_load_dwordx2 v[104:105], v13, s[24:27], s51 offen offset:64
    buffer_load_dwordx2 v[106:107], v13, s[24:27], s51 offen offset:96
    v_lshrrev_b32 v14, 1, v12
    v_lshl_add_u32 v14, v14, 5, v11
    v_lshlrev_b32 v14, 4, v14
    v_and_b32 v15, 1, v12
    v_lshl_add_u32 v14, v15, 3, v14
    s_lshl_b32 s51, s91, 12
    v_add_u32 v14, s51, v14
    v_lshlrev_b32 v15, 4, v11
    s_lshl_b32 s51, s91, 3
    v_add_u32 v15, s51, v15
    v_lshlrev_b32 v12, 2, v12
    v_bfe_u32 v11, v0, 2, 2
    v_add_u32_e64 v12, v12, v11
    v_mul_u32_u24 v16, 224, v12
    v_and_b32_e64 v11, 3, v0
    v_lshl_add_u32 v16, v11, 3, v16
    s_lshl_b32 s51, s91, 7
    s_add_u32 s51, s51, 62208
    v_add_u32 v16, s51, v16
    v_add_u32 v17, 50176, v16
    s_lshr_b32 s98, s92, 2
    s_mul_i32 s98, s98, 256
    s_add_u32 s98, s98, 16777216
    s_cmp_lg_u32 s48, 0
    s_cbranch_scc1 w0poll_23
    s_mov_b32 s61, 0
sp_24:
    s_mov_b32 s16, 0
    s_atomic_add s16, s[32:33], s98 glc
    s_add_u32 s61, s61, 1
    s_waitcnt lgkmcnt(0)
    s_cmp_gt_u32 s61, 32768
    s_cbranch_scc1 spd_25
    s_cmp_lt_u32 s16, 16
    s_cbranch_scc1 sps_27
    s_branch spd_25
sps_27:
    s_sleep 4
    s_branch sp_24
spd_25:
w0poll_23:
    s_waitcnt vmcnt(4)
    s_barrier
    s_cmp_lg_u32 s48, 2
    s_cbranch_scc1 p0_flag_28
    s_cmp_ge_u32 s100, 224
    s_cbranch_scc1 p0_flag_28
    s_lshl_b32 s49, s58, 7
    s_movk_i32 s50, 0x1000
    s_cmp_ge_u32 s100, 112
    s_cselect_b32 s50, s50, 0
    s_cselect_b32 s52, 1, 4
    s_add_u32 s49, s49, s50
    s_add_u32 s49, s49, 16801792
    s_atomic_add s52, s[32:33], s49
p0_flag_28:
    s_lshl_b32 s51, s92, 1
    s_add_u32 s51, s51, s90
    s_lshl_b32 s51, s51, 14
    s_add_u32 s51, s51, 5373952
    buffer_load_dwordx4 v[20:23], v6, s[32:35], s51 offen offset:0 sc1
    buffer_load_dwordx4 v[24:27], v6, s[32:35], s51 offen offset:1024 sc1
    buffer_load_dwordx4 v[28:31], v6, s[32:35], s51 offen offset:2048 sc1
    buffer_load_dwordx4 v[32:35], v6, s[32:35], s51 offen offset:3072 sc1
    s_add_u32 s51, s51, 4096
    buffer_load_dwordx4 v[36:39], v6, s[32:35], s51 offen offset:0 sc1
    buffer_load_dwordx4 v[40:43], v6, s[32:35], s51 offen offset:1024 sc1
    buffer_load_dwordx4 v[44:47], v6, s[32:35], s51 offen offset:2048 sc1
    buffer_load_dwordx4 v[48:51], v6, s[32:35], s51 offen offset:3072 sc1
    s_add_u32 s51, s51, 4096
    buffer_load_dwordx4 v[52:55], v6, s[32:35], s51 offen offset:0 sc1
    buffer_load_dwordx4 v[56:59], v6, s[32:35], s51 offen offset:1024 sc1
    buffer_load_dwordx4 v[60:63], v6, s[32:35], s51 offen offset:2048 sc1
    buffer_load_dwordx4 v[64:67], v6, s[32:35], s51 offen offset:3072 sc1
    s_add_u32 s51, s51, 4096
    buffer_load_dwordx4 v[68:71], v6, s[32:35], s51 offen offset:0 sc1
    buffer_load_dwordx4 v[72:75], v6, s[32:35], s51 offen offset:1024 sc1
    buffer_load_dwordx4 v[76:79], v6, s[32:35], s51 offen offset:2048 sc1
    buffer_load_dwordx4 v[80:83], v6, s[32:35], s51 offen offset:3072 sc1
    v_mov_b32 v140, -1
    v_mov_b32 v141, -1
    v_mov_b32 v142, -1
    v_mov_b32 v143, -1
    ds_read_b64_tr_b16 v[108:109], v16 offset:0
    ds_read_b64_tr_b16 v[110:111], v16 offset:3584
    ds_read_b64_tr_b16 v[112:113], v16 offset:32
    ds_read_b64_tr_b16 v[114:115], v16 offset:3616
    ds_read_b64_tr_b16 v[116:117], v16 offset:64
    ds_read_b64_tr_b16 v[118:119], v16 offset:3648
    ds_read_b64_tr_b16 v[120:121], v16 offset:96
    ds_read_b64_tr_b16 v[122:123], v16 offset:3680
    ds_read_b64_tr_b16 v[124:125], v16 offset:6272
    ds_read_b64_tr_b16 v[126:127], v16 offset:9856
    ds_read_b64_tr_b16 v[128:129], v16 offset:6304
    ds_read_b64_tr_b16 v[130:131], v16 offset:9888
    s_waitcnt lgkmcnt(8)
    s_waitcnt vmcnt(15)
    v_mfma_f32_16x16x32_bf16 v[84:87], v[108:111], v[20:23], 0
    ds_read_b64_tr_b16 v[132:133], v16 offset:6336
    ds_read_b64_tr_b16 v[134:135], v16 offset:9920
    v_mfma_f32_16x16x32_bf16 v[88:91], v[112:115], v[20:23], 0
    ds_read_b64_tr_b16 v[136:137], v16 offset:6368
    ds_read_b64_tr_b16 v[138:139], v16 offset:9952
    s_waitcnt lgkmcnt(8)
    s_nop 0
    v_mfma_f32_16x16x32_bf16 v[92:95], v[116:119], v[20:23], 0
    ds_read_b64_tr_b16 v[108:109], v16 offset:12544
    ds_read_b64_tr_b16 v[110:111], v16 offset:16128
    v_mfma_f32_16x16x32_bf16 v[96:99], v[120:123], v[20:23], 0
    ds_read_b64_tr_b16 v[112:113], v16 offset:12576
    ds_read_b64_tr_b16 v[114:115], v16 offset:16160
    s_waitcnt lgkmcnt(8)
    s_waitcnt vmcnt(14)
    v_mfma_f32_16x16x32_bf16 v[84:87], v[124:127], v[24:27], v[84:87]
    ds_read_b64_tr_b16 v[116:117], v16 offset:12608
    ds_read_b64_tr_b16 v[118:119], v16 offset:16192
    v_mfma_f32_16x16x32_bf16 v[88:91], v[128:131], v[24:27], v[88:91]
    ds_read_b64_tr_b16 v[120:121], v16 offset:12640
    ds_read_b64_tr_b16 v[122:123], v16 offset:16224
    s_waitcnt lgkmcnt(8)
    s_nop 0
    v_mfma_f32_16x16x32_bf16 v[92:95], v[132:135], v[24:27], v[92:95]
    ds_read_b64_tr_b16 v[124:125], v16 offset:18816
    ds_read_b64_tr_b16 v[126:127], v16 offset:22400
    v_mfma_f32_16x16x32_bf16 v[96:99], v[136:139], v[24:27], v[96:99]
    ds_read_b64_tr_b16 v[128:129], v16 offset:18848
    ds_read_b64_tr_b16 v[130:131], v16 offset:22432
    s_waitcnt lgkmcnt(8)
    s_waitcnt vmcnt(13)
    v_mfma_f32_16x16x32_bf16 v[84:87], v[108:111], v[28:31], v[84:87]
    ds_read_b64_tr_b16 v[132:133], v16 offset:18880
    ds_read_b64_tr_b16 v[134:135], v16 offset:22464
    v_mfma_f32_16x16x32_bf16 v[88:91], v[112:115], v[28:31], v[88:91]
    ds_read_b64_tr_b16 v[136:137], v16 offset:18912
    ds_read_b64_tr_b16 v[138:139], v16 offset:22496
    s_waitcnt lgkmcnt(8)
    s_nop 0
    v_mfma_f32_16x16x32_bf16 v[92:95], v[116:119], v[28:31], v[92:95]
    ds_read_b64_tr_b16 v[108:109], v16 offset:25088
    ds_read_b64_tr_b16 v[110:111], v16 offset:28672
    v_mfma_f32_16x16x32_bf16 v[96:99], v[120:123], v[28:31], v[96:99]
    ds_read_b64_tr_b16 v[112:113], v16 offset:25120
    ds_read_b64_tr_b16 v[114:115], v16 offset:28704
    s_waitcnt lgkmcnt(8)
    s_waitcnt vmcnt(12)
    v_mfma_f32_16x16x32_bf16 v[84:87], v[124:127], v[32:35], v[84:87]
    ds_read_b64_tr_b16 v[116:117], v16 offset:25152
    ds_read_b64_tr_b16 v[118:119], v16 offset:28736
    v_mfma_f32_16x16x32_bf16 v[88:91], v[128:131], v[32:35], v[88:91]
    ds_read_b64_tr_b16 v[120:121], v16 offset:25184
    ds_read_b64_tr_b16 v[122:123], v16 offset:28768
    s_waitcnt lgkmcnt(8)
    s_nop 0
    v_mfma_f32_16x16x32_bf16 v[92:95], v[132:135], v[32:35], v[92:95]
    ds_read_b64_tr_b16 v[124:125], v16 offset:31360
    ds_read_b64_tr_b16 v[126:127], v16 offset:34944
    v_mfma_f32_16x16x32_bf16 v[96:99], v[136:139], v[32:35], v[96:99]
    ds_read_b64_tr_b16 v[128:129], v16 offset:31392
    ds_read_b64_tr_b16 v[130:131], v16 offset:34976
    s_waitcnt lgkmcnt(8)
    s_waitcnt vmcnt(11)
    v_mfma_f32_16x16x32_bf16 v[84:87], v[108:111], v[36:39], v[84:87]
    ds_read_b64_tr_b16 v[132:133], v16 offset:31424
    ds_read_b64_tr_b16 v[134:135], v16 offset:35008
    v_mfma_f32_16x16x32_bf16 v[88:91], v[112:115], v[36:39], v[88:91]
    ds_read_b64_tr_b16 v[136:137], v16 offset:31456
    ds_read_b64_tr_b16 v[138:139], v16 offset:35040
    s_waitcnt lgkmcnt(8)
    s_nop 0
    v_mfma_f32_16x16x32_bf16 v[92:95], v[116:119], v[36:39], v[92:95]
    ds_read_b64_tr_b16 v[108:109], v16 offset:37632
    ds_read_b64_tr_b16 v[110:111], v16 offset:41216
    v_mfma_f32_16x16x32_bf16 v[96:99], v[120:123], v[36:39], v[96:99]
    ds_read_b64_tr_b16 v[112:113], v16 offset:37664
    ds_read_b64_tr_b16 v[114:115], v16 offset:41248
    s_waitcnt lgkmcnt(8)
    s_waitcnt vmcnt(10)
    v_mfma_f32_16x16x32_bf16 v[84:87], v[124:127], v[40:43], v[84:87]
    ds_read_b64_tr_b16 v[116:117], v16 offset:37696
    ds_read_b64_tr_b16 v[118:119], v16 offset:41280
    s_add_u32 s50, s95, 16384
    buffer_store_dwordx4 v[140:143], v6, s[32:35], s50 offen sc1
    v_mfma_f32_16x16x32_bf16 v[88:91], v[128:131], v[40:43], v[88:91]
    ds_read_b64_tr_b16 v[120:121], v16 offset:37728
    ds_read_b64_tr_b16 v[122:123], v16 offset:41312
    s_waitcnt lgkmcnt(8)
    s_nop 0
    v_mfma_f32_16x16x32_bf16 v[92:95], v[132:135], v[40:43], v[92:95]
    ds_read_b64_tr_b16 v[124:125], v16 offset:43904
    ds_read_b64_tr_b16 v[126:127], v16 offset:47488
    v_mfma_f32_16x16x32_bf16 v[96:99], v[136:139], v[40:43], v[96:99]
    ds_read_b64_tr_b16 v[128:129], v16 offset:43936
    ds_read_b64_tr_b16 v[130:131], v16 offset:47520
    s_waitcnt lgkmcnt(8)
    s_waitcnt vmcnt(10)
    v_mfma_f32_16x16x32_bf16 v[84:87], v[108:111], v[44:47], v[84:87]
    ds_read_b64_tr_b16 v[132:133], v16 offset:43968
    ds_read_b64_tr_b16 v[134:135], v16 offset:47552
    v_mfma_f32_16x16x32_bf16 v[88:91], v[112:115], v[44:47], v[88:91]
    ds_read_b64_tr_b16 v[136:137], v16 offset:44000
    ds_read_b64_tr_b16 v[138:139], v16 offset:47584
    s_waitcnt lgkmcnt(8)
    s_nop 0
    v_mfma_f32_16x16x32_bf16 v[92:95], v[116:119], v[44:47], v[92:95]
    ds_read_b64_tr_b16 v[108:109], v17 offset:0
    ds_read_b64_tr_b16 v[110:111], v17 offset:3584
    v_mfma_f32_16x16x32_bf16 v[96:99], v[120:123], v[44:47], v[96:99]
    ds_read_b64_tr_b16 v[112:113], v17 offset:32
    ds_read_b64_tr_b16 v[114:115], v17 offset:3616
    s_waitcnt lgkmcnt(8)
    s_waitcnt vmcnt(9)
    v_mfma_f32_16x16x32_bf16 v[84:87], v[124:127], v[48:51], v[84:87]
    ds_read_b64_tr_b16 v[116:117], v17 offset:64
    ds_read_b64_tr_b16 v[118:119], v17 offset:3648
    s_add_u32 s50, s95, 24576
    buffer_store_dwordx4 v[140:143], v6, s[32:35], s50 offen sc1
    v_mfma_f32_16x16x32_bf16 v[88:91], v[128:131], v[48:51], v[88:91]
    ds_read_b64_tr_b16 v[120:121], v17 offset:96
    ds_read_b64_tr_b16 v[122:123], v17 offset:3680
    s_waitcnt lgkmcnt(8)
    s_nop 0
    v_mfma_f32_16x16x32_bf16 v[92:95], v[132:135], v[48:51], v[92:95]
    ds_read_b64_tr_b16 v[124:125], v17 offset:6272
    ds_read_b64_tr_b16 v[126:127], v17 offset:9856
    v_mfma_f32_16x16x32_bf16 v[96:99], v[136:139], v[48:51], v[96:99]
    ds_read_b64_tr_b16 v[128:129], v17 offset:6304
    ds_read_b64_tr_b16 v[130:131], v17 offset:9888
    s_waitcnt lgkmcnt(8)
    s_waitcnt vmcnt(9)
    v_mfma_f32_16x16x32_bf16 v[84:87], v[108:111], v[52:55], v[84:87]
    ds_read_b64_tr_b16 v[132:133], v17 offset:6336
    ds_read_b64_tr_b16 v[134:135], v17 offset:9920
    v_mfma_f32_16x16x32_bf16 v[88:91], v[112:115], v[52:55], v[88:91]
    ds_read_b64_tr_b16 v[136:137], v17 offset:6368
    ds_read_b64_tr_b16 v[138:139], v17 offset:9952
    s_waitcnt lgkmcnt(8)
    s_nop 0
    v_mfma_f32_16x16x32_bf16 v[92:95], v[116:119], v[52:55], v[92:95]
    ds_read_b64_tr_b16 v[108:109], v17 offset:12544
    ds_read_b64_tr_b16 v[110:111], v17 offset:16128
    v_mfma_f32_16x16x32_bf16 v[96:99], v[120:123], v[52:55], v[96:99]
    ds_read_b64_tr_b16 v[112:113], v17 offset:12576
    ds_read_b64_tr_b16 v[114:115], v17 offset:16160
    s_waitcnt lgkmcnt(8)
    s_waitcnt vmcnt(8)
    v_mfma_f32_16x16x32_bf16 v[84:87], v[124:127], v[56:59], v[84:87]
    ds_read_b64_tr_b16 v[116:117], v17 offset:12608
    ds_read_b64_tr_b16 v[118:119], v17 offset:16192
    s_add_u32 s50, s95, 32768
    buffer_store_dwordx4 v[140:143], v6, s[32:35], s50 offen sc1
    v_mfma_f32_16x16x32_bf16 v[88:91], v[128:131], v[56:59], v[88:91]
    ds_read_b64_tr_b16 v[120:121], v17 offset:12640
    ds_read_b64_tr_b16 v[122:123], v17 offset:16224
    s_waitcnt lgkmcnt(8)
    s_nop 0
    v_mfma_f32_16x16x32_bf16 v[92:95], v[132:135], v[56:59], v[92:95]
    ds_read_b64_tr_b16 v[124:125], v17 offset:18816
    ds_read_b64_tr_b16 v[126:127], v17 offset:22400
    v_mfma_f32_16x16x32_bf16 v[96:99], v[136:139], v[56:59], v[96:99]
    ds_read_b64_tr_b16 v[128:129], v17 offset:18848
    ds_read_b64_tr_b16 v[130:131], v17 offset:22432
    s_waitcnt lgkmcnt(8)
    s_waitcnt vmcnt(8)
    v_mfma_f32_16x16x32_bf16 v[84:87], v[108:111], v[60:63], v[84:87]
    ds_read_b64_tr_b16 v[132:133], v17 offset:18880
    ds_read_b64_tr_b16 v[134:135], v17 offset:22464
    v_mfma_f32_16x16x32_bf16 v[88:91], v[112:115], v[60:63], v[88:91]
    ds_read_b64_tr_b16 v[136:137], v17 offset:18912
    ds_read_b64_tr_b16 v[138:139], v17 offset:22496
    s_waitcnt lgkmcnt(8)
    s_nop 0
    v_mfma_f32_16x16x32_bf16 v[92:95], v[116:119], v[60:63], v[92:95]
    ds_read_b64_tr_b16 v[108:109], v17 offset:25088
    ds_read_b64_tr_b16 v[110:111], v17 offset:28672
    v_mfma_f32_16x16x32_bf16 v[96:99], v[120:123], v[60:63], v[96:99]
    ds_read_b64_tr_b16 v[112:113], v17 offset:25120
    ds_read_b64_tr_b16 v[114:115], v17 offset:28704
    s_waitcnt lgkmcnt(8)
    s_waitcnt vmcnt(7)
    v_mfma_f32_16x16x32_bf16 v[84:87], v[124:127], v[64:67], v[84:87]
    ds_read_b64_tr_b16 v[116:117], v17 offset:25152
    ds_read_b64_tr_b16 v[118:119], v17 offset:28736
    s_add_u32 s50, s95, 40960
    buffer_store_dwordx4 v[140:143], v6, s[32:35], s50 offen sc1
    v_mfma_f32_16x16x32_bf16 v[88:91], v[128:131], v[64:67], v[88:91]
    ds_read_b64_tr_b16 v[120:121], v17 offset:25184
    ds_read_b64_tr_b16 v[122:123], v17 offset:28768
    s_waitcnt lgkmcnt(8)
    s_nop 0
    v_mfma_f32_16x16x32_bf16 v[92:95], v[132:135], v[64:67], v[92:95]
    ds_read_b64_tr_b16 v[124:125], v17 offset:31360
    ds_read_b64_tr_b16 v[126:127], v17 offset:34944
    v_mfma_f32_16x16x32_bf16 v[96:99], v[136:139], v[64:67], v[96:99]
    ds_read_b64_tr_b16 v[128:129], v17 offset:31392
    ds_read_b64_tr_b16 v[130:131], v17 offset:34976
    s_waitcnt lgkmcnt(8)
    s_waitcnt vmcnt(7)
    v_mfma_f32_16x16x32_bf16 v[84:87], v[108:111], v[68:71], v[84:87]
    ds_read_b64_tr_b16 v[132:133], v17 offset:31424
    ds_read_b64_tr_b16 v[134:135], v17 offset:35008
    v_mfma_f32_16x16x32_bf16 v[88:91], v[112:115], v[68:71], v[88:91]
    ds_read_b64_tr_b16 v[136:137], v17 offset:31456
    ds_read_b64_tr_b16 v[138:139], v17 offset:35040
    s_waitcnt lgkmcnt(8)
    s_nop 0
    v_mfma_f32_16x16x32_bf16 v[92:95], v[116:119], v[68:71], v[92:95]
    ds_read_b64_tr_b16 v[108:109], v17 offset:37632
    ds_read_b64_tr_b16 v[110:111], v17 offset:41216
    v_mfma_f32_16x16x32_bf16 v[96:99], v[120:123], v[68:71], v[96:99]
    ds_read_b64_tr_b16 v[112:113], v17 offset:37664
    ds_read_b64_tr_b16 v[114:115], v17 offset:41248
    s_waitcnt lgkmcnt(8)
    s_waitcnt vmcnt(6)
    v_mfma_f32_16x16x32_bf16 v[84:87], v[124:127], v[72:75], v[84:87]
    ds_read_b64_tr_b16 v[116:117], v17 offset:37696
    ds_read_b64_tr_b16 v[118:119], v17 offset:41280
    s_add_u32 s50, s95, 49152
    buffer_store_dwordx4 v[140:143], v6, s[32:35], s50 offen sc1
    v_mfma_f32_16x16x32_bf16 v[88:91], v[128:131], v[72:75], v[88:91]
    ds_read_b64_tr_b16 v[120:121], v17 offset:37728
    ds_read_b64_tr_b16 v[122:123], v17 offset:41312
    s_waitcnt lgkmcnt(8)
    s_nop 0
    v_mfma_f32_16x16x32_bf16 v[92:95], v[132:135], v[72:75], v[92:95]
    ds_read_b64_tr_b16 v[124:125], v17 offset:43904
    ds_read_b64_tr_b16 v[126:127], v17 offset:47488
    v_mfma_f32_16x16x32_bf16 v[96:99], v[136:139], v[72:75], v[96:99]
    ds_read_b64_tr_b16 v[128:129], v17 offset:43936
    ds_read_b64_tr_b16 v[130:131], v17 offset:47520
    s_waitcnt lgkmcnt(8)
    s_waitcnt vmcnt(6)
    v_mfma_f32_16x16x32_bf16 v[84:87], v[108:111], v[76:79], v[84:87]
    ds_read_b64_tr_b16 v[132:133], v17 offset:43968
    ds_read_b64_tr_b16 v[134:135], v17 offset:47552
    v_mfma_f32_16x16x32_bf16 v[88:91], v[112:115], v[76:79], v[88:91]
    ds_read_b64_tr_b16 v[136:137], v17 offset:44000
    ds_read_b64_tr_b16 v[138:139], v17 offset:47584
    s_waitcnt lgkmcnt(8)
    v_mfma_f32_16x16x32_bf16 v[92:95], v[116:119], v[76:79], v[92:95]
    v_mfma_f32_16x16x32_bf16 v[96:99], v[120:123], v[76:79], v[96:99]
    s_waitcnt lgkmcnt(4)
    s_waitcnt vmcnt(5)
    v_mfma_f32_16x16x32_bf16 v[84:87], v[124:127], v[80:83], v[84:87]
    v_mfma_f32_16x16x32_bf16 v[88:91], v[128:131], v[80:83], v[88:91]
    s_waitcnt lgkmcnt(0)
    v_mfma_f32_16x16x32_bf16 v[92:95], v[132:135], v[80:83], v[92:95]
    v_mfma_f32_16x16x32_bf16 v[96:99], v[136:139], v[80:83], v[96:99]
    buffer_load_dword v7, v8, s[32:35], 0 offen sc1
    s_barrier
    s_mul_i32 s51, s92, 28
    s_mul_i32 s52, s93, 7
    s_add_u32 s51, s51, s52
    s_lshl_b32 s51, s51, 10
    s_add_u32 s51, s51, 7471104
    v_mov_b32 v156, 0
    v_mov_b32 v157, 0
    v_lshlrev_b32 v140, 16, v100
    v_and_b32 v141, 0xffff0000, v100
    v_lshlrev_b32_e64 v142, 16, v101
    v_and_b32 v143, 0xffff0000, v101
    v_pk_add_f32 v[140:141], v[140:141], v[84:85]
    v_pk_add_f32 v[142:143], v[142:143], v[86:87]
    v_cvt_pk_bf16_f32 v100, v140, v141
    v_cvt_pk_bf16_f32 v101, v142, v143
    buffer_store_dwordx2 v[100:101], v14, s[32:35], s51 offen sc1
    v_add_f32_e64 v156, v156, v140
    v_fma_f32 v157, v140, v140, v157
    v_add_f32_e64 v156, v156, v141
    v_fma_f32 v157, v141, v141, v157
    v_add_f32_e64 v156, v156, v142
    v_fma_f32 v157, v142, v142, v157
    v_add_f32_e64 v156, v156, v143
    v_fma_f32 v157, v143, v143, v157
    v_lshlrev_b32_e64 v144, 16, v102
    v_and_b32 v145, 0xffff0000, v102
    v_lshlrev_b32_e64 v146, 16, v103
    v_and_b32 v147, 0xffff0000, v103
    v_pk_add_f32 v[144:145], v[144:145], v[88:89]
    v_pk_add_f32 v[146:147], v[146:147], v[90:91]
    v_cvt_pk_bf16_f32 v102, v144, v145
    v_cvt_pk_bf16_f32 v103, v146, v147
    s_add_u32 s51, s51, 1024
    buffer_store_dwordx2 v[102:103], v14, s[32:35], s51 offen sc1
    v_add_f32_e64 v156, v156, v144
    v_fma_f32 v157, v144, v144, v157
    v_add_f32_e64 v156, v156, v145
    v_fma_f32 v157, v145, v145, v157
    v_add_f32_e64 v156, v156, v146
    v_fma_f32 v157, v146, v146, v157
    v_add_f32_e64 v156, v156, v147
    v_fma_f32 v157, v147, v147, v157
    v_lshlrev_b32_e64 v148, 16, v104
    v_and_b32 v149, 0xffff0000, v104
    v_lshlrev_b32_e64 v150, 16, v105
    v_and_b32 v151, 0xffff0000, v105
    v_pk_add_f32 v[148:149], v[148:149], v[92:93]
    v_pk_add_f32 v[150:151], v[150:151], v[94:95]
    v_cvt_pk_bf16_f32 v104, v148, v149
    v_cvt_pk_bf16_f32 v105, v150, v151
    s_add_u32 s51, s51, 1024
    buffer_store_dwordx2 v[104:105], v14, s[32:35], s51 offen sc1
    v_add_f32_e64 v156, v156, v148
    v_fma_f32 v157, v148, v148, v157
    v_add_f32_e64 v156, v156, v149
    v_fma_f32 v157, v149, v149, v157
    v_add_f32_e64 v156, v156, v150
    v_fma_f32 v157, v150, v150, v157
    v_add_f32_e64 v156, v156, v151
    v_fma_f32 v157, v151, v151, v157
    s_cmp_lg_u32 s91, 0
    s_cbranch_scc1 p2_skip_29
    v_lshlrev_b32_e64 v152, 16, v106
    v_and_b32 v153, 0xffff0000, v106
    v_lshlrev_b32_e64 v154, 16, v107
    v_and_b32 v155, 0xffff0000, v107
    v_pk_add_f32 v[152:153], v[152:153], v[96:97]
    v_pk_add_f32 v[154:155], v[154:155], v[98:99]
    v_cvt_pk_bf16_f32 v106, v152, v153
    v_cvt_pk_bf16_f32 v107, v154, v155
    s_add_u32 s51, s51, 1024
    buffer_store_dwordx2 v[106:107], v14, s[32:35], s51 offen sc1
    v_add_f32_e64 v156, v156, v152
    v_fma_f32 v157, v152, v152, v157
    v_add_f32_e64 v156, v156, v153
    v_fma_f32 v157, v153, v153, v157
    v_add_f32_e64 v156, v156, v154
    v_fma_f32 v157, v154, v154, v157
    v_add_f32_e64 v156, v156, v155
    v_fma_f32 v157, v155, v155, v157
p2_skip_29:
    v_mov_b32 v158, v156
    s_nop 1
    v_permlane16_swap_b32 v156, v158
    v_add_f32 v156, v156, v158
    v_mov_b32 v158, v156
    s_nop 1
    v_permlane32_swap_b32 v156, v158
    v_add_f32 v156, v156, v158
    v_mov_b32 v159, v157
    s_nop 1
    v_permlane16_swap_b32 v157, v159
    v_add_f32 v157, v157, v159
    v_mov_b32 v159, v157
    s_nop 1
    v_permlane32_swap_b32 v157, v159
    v_add_f32_e64 v157, v157, v159
    s_lshl_b32 s51, s92, 11
    s_lshl_b32 s52, s93, 9
    s_add_u32 s51, s51, s52
    s_add_u32 s51, s51, 16809984
    s_mov_b64 exec, 0xffff
    buffer_store_dwordx2 v[156:157], v15, s[32:35], s51 offen sc1
    s_mov_b64 exec, -1
    s_waitcnt vmcnt(4)
    v_cmp_ne_u32 vcc, 16, v7
    s_nop 0
    s_cmp_eq_u64 vcc, 0
    s_cbranch_scc1 polld_31
    s_mov_b32 s61, 0
poll_30:
    buffer_load_dword v7, v8, s[32:35], 0 offen sc1
    s_waitcnt vmcnt(0)
    v_cmp_ne_u32 vcc, 16, v7
    s_add_u32 s61, s61, 1
    s_cmp_gt_u32 s61, 32768
    s_cbranch_scc1 polld_31
    s_cmp_eq_u64 vcc, 0
    s_cbranch_scc1 polld_31
    s_sleep 2
    s_branch poll_30
polld_31:
    s_add_u32 m0, s89, 0
    s_add_u32 s100, s60, 0
    s_nop 0
    buffer_load_dwordx4 v6, s[32:35], s100 offen offset:0 sc1 lds
    buffer_load_dwordx4 v6, s[32:35], s100 offen offset:1024 sc1 lds
    buffer_load_dwordx4 v6, s[32:35], s100 offen offset:2048 sc1 lds
    buffer_load_dwordx4 v6, s[32:35], s100 offen offset:3072 sc1 lds
    s_add_u32 m0, s89, 4096
    s_add_u32 s100, s60, 4096
    buffer_load_dwordx4 v6, s[32:35], s100 offen offset:0 sc1 lds
    buffer_load_dwordx4 v6, s[32:35], s100 offen offset:1024 sc1 lds
    buffer_load_dwordx4 v6, s[32:35], s100 offen offset:2048 sc1 lds
    s_waitcnt vmcnt(7)
    s_barrier
    s_cmp_lg_u32 s48, 2
    s_cbranch_scc1 sig_32
    s_mov_b64 exec, 1
    buffer_atomic_add v4, v5, s[32:35], s94 offen sc1
    s_mov_b64 exec, -1
sig_32:
    s_lshl_b32 s49, s48, 8
    s_nop 0
    v_lshl_add_u32 v11, v0, 2, s49
    s_mul_i32 s49, s54, 896
    s_add_u32 s49, s49, 5275648
    buffer_load_dword v240, v11, s[32:35], s49 offen sc1
    s_add_u32 s49, s49, 14336
    buffer_load_dword v241, v11, s[32:35], s49 offen sc1
    s_add_u32 s49, s49, 14336
    buffer_load_dword v242, v11, s[32:35], s49 offen sc1
    s_add_u32 s49, s49, 14336
    buffer_load_dword v243, v11, s[32:35], s49 offen sc1
    s_add_u32 m0, s89, 28672
    s_add_u32 s100, s60, 28672
    buffer_load_dwordx4 v6, s[32:35], s100 offen offset:0 sc1 lds
    buffer_load_dwordx4 v6, s[32:35], s100 offen offset:1024 sc1 lds
    buffer_load_dwordx4 v6, s[32:35], s100 offen offset:2048 sc1 lds
    buffer_load_dwordx4 v6, s[32:35], s100 offen offset:3072 sc1 lds
    s_add_u32 m0, s89, 32768
    s_add_u32 s100, s60, 32768
    buffer_load_dwordx4 v6, s[32:35], s100 offen offset:0 sc1 lds
    buffer_load_dwordx4 v6, s[32:35], s100 offen offset:1024 sc1 lds
    buffer_load_dwordx4 v6, s[32:35], s100 offen offset:2048 sc1 lds
    s_add_u32 m0, s89, 57344
    s_add_u32 s100, s60, 57344
    buffer_load_dwordx4 v6, s[32:35], s100 offen offset:0 sc1 lds
    buffer_load_dwordx4 v6, s[32:35], s100 offen offset:1024 sc1 lds
    buffer_load_dwordx4 v6, s[32:35], s100 offen offset:2048 sc1 lds
    buffer_load_dwordx4 v6, s[32:35], s100 offen offset:3072 sc1 lds
    s_add_u32 m0, s89, 61440
    s_add_u32 s100, s60, 61440
    buffer_load_dwordx4 v6, s[32:35], s100 offen offset:0 sc1 lds
    buffer_load_dwordx4 v6, s[32:35], s100 offen offset:1024 sc1 lds
    buffer_load_dwordx4 v6, s[32:35], s100 offen offset:2048 sc1 lds
    s_waitcnt vmcnt(16)
    v_add_f32 v240, v240, v241
    s_waitcnt vmcnt(14)
    v_add_f32 v242, v242, v243
    v_add_f32_e64 v240, v240, v242
    v_add_u32 v11, 143360, v11
    ds_write_b32 v11, v240
    s_add_u32 s101, s81, 0
    s_nop 0
    buffer_load_dwordx4 a[0:3], v6, s[32:35], s101 offen offset:0 sc1
    buffer_load_dwordx4 a[4:7], v6, s[32:35], s101 offen offset:1024 sc1
    buffer_load_dwordx4 a[8:11], v6, s[32:35], s101 offen offset:2048 sc1
    buffer_load_dwordx4 a[12:15], v6, s[32:35], s101 offen offset:3072 sc1
    s_add_u32 s101, s81, 4096
    buffer_load_dwordx4 a[16:19], v6, s[32:35], s101 offen offset:0 sc1
    buffer_load_dwordx4 a[20:23], v6, s[32:35], s101 offen offset:1024 sc1
    buffer_load_dwordx4 a[24:27], v6, s[32:35], s101 offen offset:2048 sc1
    buffer_load_dwordx4 a[28:31], v6, s[32:35], s101 offen offset:3072 sc1
    s_add_u32 s101, s81, 8192
    buffer_load_dwordx4 a[32:35], v6, s[32:35], s101 offen offset:0 sc1
    buffer_load_dwordx4 a[36:39], v6, s[32:35], s101 offen offset:1024 sc1
    buffer_load_dwordx4 a[40:43], v6, s[32:35], s101 offen offset:2048 sc1
    buffer_load_dwordx4 a[44:47], v6, s[32:35], s101 offen offset:3072 sc1
    s_add_u32 s101, s81, 12288
    buffer_load_dwordx4 a[48:51], v6, s[32:35], s101 offen offset:0 sc1
    buffer_load_dwordx4 a[52:55], v6, s[32:35], s101 offen offset:1024 sc1
    buffer_load_dwordx4 a[56:59], v6, s[32:35], s101 offen offset:2048 sc1
    buffer_load_dwordx4 a[60:63], v6, s[32:35], s101 offen offset:3072 sc1
    s_add_u32 s101, s81, 16384
    buffer_load_dwordx4 a[64:67], v6, s[32:35], s101 offen offset:0 sc1
    buffer_load_dwordx4 a[68:71], v6, s[32:35], s101 offen offset:1024 sc1
    buffer_load_dwordx4 a[72:75], v6, s[32:35], s101 offen offset:2048 sc1
    buffer_load_dwordx4 a[76:79], v6, s[32:35], s101 offen offset:3072 sc1
    s_add_u32 s101, s81, 20480
    buffer_load_dwordx4 a[80:83], v6, s[32:35], s101 offen offset:0 sc1
    buffer_load_dwordx4 a[84:87], v6, s[32:35], s101 offen offset:1024 sc1
    buffer_load_dwordx4 a[88:91], v6, s[32:35], s101 offen offset:2048 sc1
    buffer_load_dwordx4 a[92:95], v6, s[32:35], s101 offen offset:3072 sc1
    v_lshrrev_b32 v12, 5, v0
    v_lshlrev_b32 v12, 4, v12
    v_add_u32 v12, 143360, v12
    v_and_b32 v11, 3, v0
    v_lshlrev_b32 v20, 2, v11
    v_and_b32 v11, 31, v0
    v_lshlrev_b32 v11, 4, v11
    s_mul_i32 s98, s53, 256
    s_add_u32 s98, s98, 16785408
    s_cmp_lg_u32 s48, 1
    s_cbranch_scc1 w1poll_33
    s_mov_b32 s61, 0
sp_34:
    s_mov_b32 s16, 0
    s_atomic_add s16, s[32:33], s98 glc
    s_add_u32 s61, s61, 1
    s_waitcnt lgkmcnt(0)
    s_cmp_gt_u32 s61, 32768
    s_cbranch_scc1 spd_35
    s_cmp_lt_u32 s16, 16
    s_cbranch_scc1 sps_37
    s_branch spd_35
sps_37:
    s_sleep 4
    s_branch sp_34
spd_35:
w1poll_33:
    s_waitcnt vmcnt(24)
    s_waitcnt lgkmcnt(0)
    s_barrier
    s_mul_i32 s49, s97, 28672
    s_add_u32 s49, s49, 7471104
    s_lshl_b32 s50, s97, 11
    s_add_u32 s50, s50, 16809984
    buffer_load_dwordx4 v[24:27], v6, s[32:35], s49 offen offset:0 sc1
    buffer_load_dwordx4 v[28:31], v6, s[32:35], s49 offen offset:1024 sc1
    buffer_load_dwordx4 v[32:35], v6, s[32:35], s49 offen offset:2048 sc1
    buffer_load_dwordx4 v[36:39], v6, s[32:35], s49 offen offset:3072 sc1
    s_add_u32 s49, s49, 4096
    buffer_load_dwordx4 v[40:43], v6, s[32:35], s49 offen offset:0 sc1
    buffer_load_dwordx4 v[44:47], v6, s[32:35], s49 offen offset:1024 sc1
    buffer_load_dwordx4 v[48:51], v6, s[32:35], s49 offen offset:2048 sc1
    buffer_load_dwordx4 v[52:55], v6, s[32:35], s49 offen offset:3072 sc1
    s_add_u32 s49, s49, 4096
    buffer_load_dwordx4 v[56:59], v6, s[32:35], s49 offen offset:0 sc1
    buffer_load_dwordx4 v[60:63], v6, s[32:35], s49 offen offset:1024 sc1
    buffer_load_dwordx4 v[64:67], v6, s[32:35], s49 offen offset:2048 sc1
    buffer_load_dwordx4 v[68:71], v6, s[32:35], s49 offen offset:3072 sc1
    s_add_u32 s49, s49, 4096
    buffer_load_dwordx4 v[72:75], v6, s[32:35], s49 offen offset:0 sc1
    buffer_load_dwordx4 v[76:79], v6, s[32:35], s49 offen offset:1024 sc1
    buffer_load_dwordx4 v[80:83], v6, s[32:35], s49 offen offset:2048 sc1
    buffer_load_dwordx4 v[84:87], v6, s[32:35], s49 offen offset:3072 sc1
    s_add_u32 s49, s49, 4096
    buffer_load_dwordx4 v[88:91], v6, s[32:35], s49 offen offset:0 sc1
    buffer_load_dwordx4 v[92:95], v6, s[32:35], s49 offen offset:1024 sc1
    buffer_load_dwordx4 v[96:99], v6, s[32:35], s49 offen offset:2048 sc1
    buffer_load_dwordx4 v[100:103], v6, s[32:35], s49 offen offset:3072 sc1
    s_add_u32 s49, s49, 4096
    buffer_load_dwordx4 v[104:107], v6, s[32:35], s49 offen offset:0 sc1
    buffer_load_dwordx4 v[108:111], v6, s[32:35], s49 offen offset:1024 sc1
    buffer_load_dwordx4 v[112:115], v6, s[32:35], s49 offen offset:2048 sc1
    buffer_load_dwordx4 v[116:119], v6, s[32:35], s49 offen offset:3072 sc1
    s_add_u32 s49, s49, 4096
    buffer_load_dwordx4 v[120:123], v6, s[32:35], s49 offen offset:0 sc1
    buffer_load_dwordx4 v[124:127], v6, s[32:35], s49 offen offset:1024 sc1
    buffer_load_dwordx4 v[128:131], v6, s[32:35], s49 offen offset:2048 sc1
    buffer_load_dwordx4 v[132:135], v6, s[32:35], s49 offen offset:3072 sc1
    buffer_load_dwordx4 v[224:227], v11, s[32:35], s50 offen offset:0 sc1
    buffer_load_dwordx4 v[228:231], v11, s[32:35], s50 offen offset:512 sc1
    buffer_load_dwordx4 v[232:235], v11, s[32:35], s50 offen offset:1024 sc1
    buffer_load_dwordx4 v[236:239], v11, s[32:35], s50 offen offset:1536 sc1
    s_mov_b32 s78, 0x3b124925
    s_mov_b32 s79, 0x3727c5ac
    s_mov_b32 s80, 0xbfb8aa3b
    s_lshr_b32 s98, s83, 1
    s_mul_i32 s98, s98, 256
    s_lshl_b32 s49, s48, 4
    s_add_u32 s98, s98, s49
    s_add_u32 s98, s98, 16793600
    v_add_u32 v13, 0, v6
    v_add_u32 v14, 28672, v6
    ds_read_b128 v[184:187], v13 offset:0
    ds_read_b128 v[188:191], v14 offset:0
    ds_read_b128 v[192:195], v13 offset:1024
    ds_read_b128 v[196:199], v14 offset:1024
    ds_read_b128 v[200:203], v13 offset:2048
    ds_read_b128 v[204:207], v14 offset:2048
    ds_read_b128 v[208:211], v13 offset:3072
    ds_read_b128 v[212:215], v14 offset:3072
    s_waitcnt lgkmcnt(4)
    s_waitcnt vmcnt(31)
    v_mfma_f32_32x32x16_bf16 v[136:151], v[184:187], v[24:27], 0
    ds_read_b128 v[216:219], v13 offset:4096
    v_mfma_f32_32x32x16_bf16 v[152:167], v[188:191], v[24:27], 0
    ds_read_b128 v[220:223], v14 offset:4096
    s_waitcnt vmcnt(30)
    v_mfma_f32_32x32x16_bf16 v[136:151], v[192:195], v[28:31], v[136:151]
    ds_read_b128 v[184:187], v13 offset:5120
    v_mfma_f32_32x32x16_bf16 v[152:167], v[196:199], v[28:31], v[152:167]
    ds_read_b128 v[188:191], v14 offset:5120
    s_waitcnt lgkmcnt(4)
    s_waitcnt vmcnt(29)
    v_mfma_f32_32x32x16_bf16 v[136:151], v[200:203], v[32:35], v[136:151]
    ds_read_b128 v[192:195], v13 offset:6144
    v_mfma_f32_32x32x16_bf16 v[152:167], v[204:207], v[32:35], v[152:167]
    ds_read_b128 v[196:199], v14 offset:6144
    s_waitcnt vmcnt(28)
    v_mfma_f32_32x32x16_bf16 v[136:151], v[208:211], v[36:39], v[136:151]
    ds_read_b128 v[200:203], v13 offset:7168
    v_mfma_f32_32x32x16_bf16 v[152:167], v[212:215], v[36:39], v[152:167]
    ds_read_b128 v[204:207], v14 offset:7168
    s_waitcnt lgkmcnt(4)
    s_waitcnt vmcnt(27)
    v_mfma_f32_32x32x16_bf16 v[136:151], v[216:219], v[40:43], v[136:151]
    ds_read_b128 v[208:211], v13 offset:8192
    v_mfma_f32_32x32x16_bf16 v[152:167], v[220:223], v[40:43], v[152:167]
    ds_read_b128 v[212:215], v14 offset:8192
    s_waitcnt vmcnt(26)
    v_mfma_f32_32x32x16_bf16 v[136:151], v[184:187], v[44:47], v[136:151]
    ds_read_b128 v[216:219], v13 offset:9216
    v_mfma_f32_32x32x16_bf16 v[152:167], v[188:191], v[44:47], v[152:167]
    ds_read_b128 v[220:223], v14 offset:9216
    s_waitcnt lgkmcnt(4)
    s_waitcnt vmcnt(25)
    v_mfma_f32_32x32x16_bf16 v[136:151], v[192:195], v[48:51], v[136:151]
    ds_read_b128 v[184:187], v13 offset:10240
    v_mfma_f32_32x32x16_bf16 v[152:167], v[196:199], v[48:51], v[152:167]
    ds_read_b128 v[188:191], v14 offset:10240
    s_waitcnt vmcnt(24)
    v_mfma_f32_32x32x16_bf16 v[136:151], v[200:203], v[52:55], v[136:151]
    ds_read_b128 v[192:195], v13 offset:11264
    v_mfma_f32_32x32x16_bf16 v[152:167], v[204:207], v[52:55], v[152:167]
    ds_read_b128 v[196:199], v14 offset:11264
    s_waitcnt lgkmcnt(4)
    s_waitcnt vmcnt(23)
    v_mfma_f32_32x32x16_bf16 v[136:151], v[208:211], v[56:59], v[136:151]
    ds_read_b128 v[200:203], v13 offset:12288
    v_mfma_f32_32x32x16_bf16 v[152:167], v[212:215], v[56:59], v[152:167]
    ds_read_b128 v[204:207], v14 offset:12288
    s_waitcnt vmcnt(22)
    v_mfma_f32_32x32x16_bf16 v[136:151], v[216:219], v[60:63], v[136:151]
    ds_read_b128 v[208:211], v13 offset:13312
    v_mfma_f32_32x32x16_bf16 v[152:167], v[220:223], v[60:63], v[152:167]
    ds_read_b128 v[212:215], v14 offset:13312
    s_waitcnt lgkmcnt(4)
    s_waitcnt vmcnt(21)
    s_nop 0
    v_mfma_f32_32x32x16_bf16 v[136:151], v[184:187], v[64:67], v[136:151]
    ds_read_b128 v[216:219], v13 offset:14336
    v_mfma_f32_32x32x16_bf16 v[152:167], v[188:191], v[64:67], v[152:167]
    ds_read_b128 v[220:223], v14 offset:14336
    s_add_u32 m0, s89, 86016
    s_add_u32 s100, s60, 86016
    buffer_load_dwordx4 v6, s[32:35], s100 offen offset:0 sc1 lds
    s_waitcnt vmcnt(21)
    v_mfma_f32_32x32x16_bf16 v[136:151], v[192:195], v[68:71], v[136:151]
    ds_read_b128 v[184:187], v13 offset:15360
    v_mfma_f32_32x32x16_bf16 v[152:167], v[196:199], v[68:71], v[152:167]
    ds_read_b128 v[188:191], v14 offset:15360
    buffer_load_dwordx4 v6, s[32:35], s100 offen offset:1024 sc1 lds
    s_waitcnt lgkmcnt(4)
    s_waitcnt vmcnt(21)
    v_mfma_f32_32x32x16_bf16 v[136:151], v[200:203], v[72:75], v[136:151]
    ds_read_b128 v[192:195], v13 offset:16384
    v_mfma_f32_32x32x16_bf16 v[152:167], v[204:207], v[72:75], v[152:167]
    ds_read_b128 v[196:199], v14 offset:16384
    buffer_load_dwordx4 v6, s[32:35], s100 offen offset:2048 sc1 lds
    s_waitcnt vmcnt(21)
    v_mfma_f32_32x32x16_bf16 v[136:151], v[208:211], v[76:79], v[136:151]
    ds_read_b128 v[200:203], v13 offset:17408
    v_mfma_f32_32x32x16_bf16 v[152:167], v[212:215], v[76:79], v[152:167]
    ds_read_b128 v[204:207], v14 offset:17408
    buffer_load_dwordx4 v6, s[32:35], s100 offen offset:3072 sc1 lds
    s_waitcnt lgkmcnt(4)
    s_waitcnt vmcnt(21)
    v_mfma_f32_32x32x16_bf16 v[136:151], v[216:219], v[80:83], v[136:151]
    ds_read_b128 v[208:211], v13 offset:18432
    v_mfma_f32_32x32x16_bf16 v[152:167], v[220:223], v[80:83], v[152:167]
    ds_read_b128 v[212:215], v14 offset:18432
    s_add_u32 m0, s89, 90112
    s_add_u32 s100, s60, 90112
    buffer_load_dwordx4 v6, s[32:35], s100 offen offset:0 sc1 lds
    s_waitcnt vmcnt(21)
    v_mfma_f32_32x32x16_bf16 v[136:151], v[184:187], v[84:87], v[136:151]
    ds_read_b128 v[216:219], v13 offset:19456
    v_mfma_f32_32x32x16_bf16 v[152:167], v[188:191], v[84:87], v[152:167]
    ds_read_b128 v[220:223], v14 offset:19456
    buffer_load_dwordx4 v6, s[32:35], s100 offen offset:1024 sc1 lds
    s_waitcnt lgkmcnt(4)
    s_waitcnt vmcnt(21)
    v_mfma_f32_32x32x16_bf16 v[136:151], v[192:195], v[88:91], v[136:151]
    ds_read_b128 v[184:187], v13 offset:20480
    v_mfma_f32_32x32x16_bf16 v[152:167], v[196:199], v[88:91], v[152:167]
    ds_read_b128 v[188:191], v14 offset:20480
    buffer_load_dwordx4 v6, s[32:35], s100 offen offset:2048 sc1 lds
    s_waitcnt vmcnt(21)
    v_mfma_f32_32x32x16_bf16 v[136:151], v[200:203], v[92:95], v[136:151]
    ds_read_b128 v[192:195], v13 offset:21504
    v_mfma_f32_32x32x16_bf16 v[152:167], v[204:207], v[92:95], v[152:167]
    ds_read_b128 v[196:199], v14 offset:21504
    s_add_u32 m0, s89, 114688
    s_add_u32 s100, s60, 114688
    buffer_load_dwordx4 v6, s[32:35], s100 offen offset:0 sc1 lds
    s_waitcnt lgkmcnt(4)
    s_waitcnt vmcnt(21)
    v_mfma_f32_32x32x16_bf16 v[136:151], v[208:211], v[96:99], v[136:151]
    ds_read_b128 v[200:203], v13 offset:22528
    v_mfma_f32_32x32x16_bf16 v[152:167], v[212:215], v[96:99], v[152:167]
    ds_read_b128 v[204:207], v14 offset:22528
    buffer_load_dwordx4 v6, s[32:35], s100 offen offset:1024 sc1 lds
    s_waitcnt vmcnt(21)
    v_mfma_f32_32x32x16_bf16 v[136:151], v[216:219], v[100:103], v[136:151]
    ds_read_b128 v[208:211], v13 offset:23552
    v_mfma_f32_32x32x16_bf16 v[152:167], v[220:223], v[100:103], v[152:167]
    ds_read_b128 v[212:215], v14 offset:23552
    buffer_load_dwordx4 v6, s[32:35], s100 offen offset:2048 sc1 lds
    s_waitcnt lgkmcnt(4)
    s_waitcnt vmcnt(21)
    v_mfma_f32_32x32x16_bf16 v[136:151], v[184:187], v[104:107], v[136:151]
    ds_read_b128 v[216:219], v13 offset:24576
    v_mfma_f32_32x32x16_bf16 v[152:167], v[188:191], v[104:107], v[152:167]
    ds_read_b128 v[220:223], v14 offset:24576
    buffer_load_dwordx4 v6, s[32:35], s100 offen offset:3072 sc1 lds
    s_waitcnt vmcnt(21)
    v_mfma_f32_32x32x16_bf16 v[136:151], v[192:195], v[108:111], v[136:151]
    ds_read_b128 v[184:187], v13 offset:25600
    v_mfma_f32_32x32x16_bf16 v[152:167], v[196:199], v[108:111], v[152:167]
    ds_read_b128 v[188:191], v14 offset:25600
    s_add_u32 m0, s89, 118784
    s_add_u32 s100, s60, 118784
    buffer_load_dwordx4 v6, s[32:35], s100 offen offset:0 sc1 lds
    s_waitcnt lgkmcnt(4)
    s_waitcnt vmcnt(21)
    v_mfma_f32_32x32x16_bf16 v[136:151], v[200:203], v[112:115], v[136:151]
    ds_read_b128 v[192:195], v13 offset:26624
    s_waitcnt vmcnt(15)
    v_add_f32 v224, v224, v226
    v_add_f32 v225, v225, v227
    s_waitcnt vmcnt(14)
    v_add_f32 v224, v224, v228
    v_add_f32 v225, v225, v229
    v_mfma_f32_32x32x16_bf16 v[152:167], v[204:207], v[112:115], v[152:167]
    ds_read_b128 v[196:199], v14 offset:26624
    buffer_load_dwordx4 v6, s[32:35], s100 offen offset:1024 sc1 lds
    v_add_f32 v224, v224, v230
    v_add_f32 v225, v225, v231
    s_waitcnt vmcnt(14)
    v_add_f32 v224, v224, v232
    v_mfma_f32_32x32x16_bf16 v[136:151], v[208:211], v[116:119], v[136:151]
    ds_read_b128 v[200:203], v13 offset:27648
    v_add_f32 v225, v225, v233
    v_add_f32 v224, v224, v234
    v_add_f32 v225, v225, v235
    s_waitcnt vmcnt(13)
    v_add_f32 v224, v224, v236
    v_add_f32 v225, v225, v237
    v_mfma_f32_32x32x16_bf16 v[152:167], v[212:215], v[116:119], v[152:167]
    ds_read_b128 v[204:207], v14 offset:27648
    buffer_load_dwordx4 v6, s[32:35], s100 offen offset:2048 sc1 lds
    v_add_f32 v224, v224, v238
    v_add_f32 v225, v225, v239
    v_mul_f32 v15, s78, v224
    s_waitcnt lgkmcnt(4)
    v_mfma_f32_32x32x16_bf16 v[136:151], v[216:219], v[120:123], v[136:151]
    v_add_u32 v13, 57344, v6
    ds_read_b128 v[208:211], v13 offset:0
    v_mul_f32_e64 v17, s78, v225
    v_fma_f32 v17, -v15, v15, v17
    v_max_f32_e64 v17, 0, v17
    v_mfma_f32_32x32x16_bf16 v[152:167], v[220:223], v[120:123], v[152:167]
    ds_read_b128 v[212:215], v13 offset:1024
    v_add_f32 v17, s79, v17
    v_rsq_f32 v16, v17
    v_sub_f32 v15, 0, v15
    v_mul_f32 v16, s80, v16
    v_mfma_f32_32x32x16_bf16 v[136:151], v[184:187], v[124:127], v[136:151]
    ds_read_b128 v[216:219], v13 offset:2048
    v_mfma_f32_32x32x16_bf16 v[152:167], v[188:191], v[124:127], v[152:167]
    ds_read_b128 v[220:223], v13 offset:3072
    s_waitcnt lgkmcnt(4)
    s_nop 0
    v_mfma_f32_32x32x16_bf16 v[136:151], v[192:195], v[128:131], v[136:151]
    ds_read_b128 v[184:187], v13 offset:4096
    v_mfma_f32_32x32x16_bf16 v[152:167], v[196:199], v[128:131], v[152:167]
    ds_read_b128 v[188:191], v13 offset:5120
    v_mfma_f32_32x32x16_bf16 v[136:151], v[200:203], v[132:135], v[136:151]
    ds_read_b128 v[192:195], v13 offset:6144
    v_mfma_f32_32x32x16_bf16 v[152:167], v[204:207], v[132:135], v[152:167]
    ds_read_b128 v[196:199], v13 offset:7168
    s_barrier
    s_waitcnt lgkmcnt(4)
    v_mfma_f32_32x32x16_bf16 v[168:183], v[208:211], v[24:27], 0
    ds_read_b128 v[200:203], v13 offset:8192
    ds_read_b128 v[224:227], v12 offset:0
    ds_read_b128 v[228:231], v12 offset:32
    ds_read_b128 v[232:235], v12 offset:64
    ds_read_b128 v[236:239], v12 offset:96
    v_mfma_f32_32x32x16_bf16 v[168:183], v[212:215], v[28:31], v[168:183]
    ds_read_b128 v[204:207], v13 offset:9216
    v_mfma_f32_32x32x16_bf16 v[168:183], v[216:219], v[32:35], v[168:183]
    ds_read_b128 v[208:211], v13 offset:10240
    s_add_u32 m0, s89, 0
    s_add_u32 s100, s60, 143360
    buffer_load_dwordx4 v6, s[32:35], s100 offen offset:0 sc1 lds
    v_mfma_f32_32x32x16_bf16 v[168:183], v[220:223], v[36:39], v[168:183]
    ds_read_b128 v[212:215], v13 offset:11264
    s_waitcnt lgkmcnt(6)
    v_fma_f32 v224, v15, v224, v136
    v_fma_f32 v225, v15, v225, v137
    v_fma_f32 v226, v15, v226, v138
    v_fma_f32 v227, v15, v227, v139
    s_waitcnt lgkmcnt(5)
    s_nop 0
    v_fma_f32 v228, v15, v228, v140
    v_mfma_f32_32x32x16_bf16 v[168:183], v[184:187], v[40:43], v[168:183]
    ds_read_b128 v[216:219], v13 offset:12288
    v_fma_f32 v229, v15, v229, v141
    v_fma_f32 v230, v15, v230, v142
    v_fma_f32 v231, v15, v231, v143
    s_waitcnt lgkmcnt(5)
    s_nop 0
    v_fma_f32 v232, v15, v232, v144
    v_mfma_f32_32x32x16_bf16 v[168:183], v[188:191], v[44:47], v[168:183]
    ds_read_b128 v[220:223], v13 offset:13312
    buffer_load_dwordx4 v6, s[32:35], s100 offen offset:1024 sc1 lds
    v_fma_f32 v233, v15, v233, v145
    v_fma_f32 v234, v15, v234, v146
    v_fma_f32 v235, v15, v235, v147
    v_mfma_f32_32x32x16_bf16 v[168:183], v[192:195], v[48:51], v[168:183]
    ds_read_b128 v[184:187], v13 offset:14336
    s_waitcnt lgkmcnt(6)
    v_fma_f32 v236, v15, v236, v148
    v_fma_f32 v237, v15, v237, v149
    v_fma_f32 v238, v15, v238, v150
    v_fma_f32 v239, v15, v239, v151
    v_mul_f32 v240, v224, v16
    v_mfma_f32_32x32x16_bf16 v[168:183], v[196:199], v[52:55], v[168:183]
    ds_read_b128 v[188:191], v13 offset:15360
    v_mul_f32 v241, v225, v16
    v_mul_f32 v242, v226, v16
    v_mul_f32 v243, v227, v16
    v_mul_f32 v244, v228, v16
    v_mul_f32 v245, v229, v16
    s_waitcnt lgkmcnt(4)
    v_mfma_f32_32x32x16_bf16 v[168:183], v[200:203], v[56:59], v[168:183]
    ds_read_b128 v[192:195], v13 offset:16384
    buffer_load_dwordx4 v6, s[32:35], s100 offen offset:2048 sc1 lds
    v_mul_f32 v246, v230, v16
    v_mul_f32 v247, v231, v16
    v_mfma_f32_32x32x16_bf16 v[168:183], v[204:207], v[60:63], v[168:183]
    ds_read_b128 v[196:199], v13 offset:17408
    v_exp_f32 v240, v240
    v_exp_f32 v241, v241
    v_mfma_f32_32x32x16_bf16 v[168:183], v[208:211], v[64:67], v[168:183]
    ds_read_b128 v[200:203], v13 offset:18432
    v_exp_f32 v242, v242
    v_exp_f32 v243, v243
    v_mfma_f32_32x32x16_bf16 v[168:183], v[212:215], v[68:71], v[168:183]
    ds_read_b128 v[204:207], v13 offset:19456
    buffer_load_dwordx4 v6, s[32:35], s100 offen offset:3072 sc1 lds
    v_exp_f32 v244, v244
    s_waitcnt lgkmcnt(4)
    v_mfma_f32_32x32x16_bf16 v[168:183], v[216:219], v[72:75], v[168:183]
    ds_read_b128 v[208:211], v13 offset:20480
    v_exp_f32 v245, v245
    v_exp_f32 v246, v246
    v_mfma_f32_32x32x16_bf16 v[168:183], v[220:223], v[76:79], v[168:183]
    ds_read_b128 v[212:215], v13 offset:21504
    v_exp_f32 v247, v247
    v_mul_f32 v224, v224, v232
    v_mul_f32 v225, v225, v233
    v_mul_f32 v226, v226, v234
    v_mfma_f32_32x32x16_bf16 v[168:183], v[184:187], v[80:83], v[168:183]
    ds_read_b128 v[216:219], v13 offset:22528
    s_add_u32 m0, s89, 4096
    s_add_u32 s100, s60, 147456
    buffer_load_dwordx4 v6, s[32:35], s100 offen offset:0 sc1 lds
    v_mul_f32_e64 v227, v227, v235
    v_mfma_f32_32x32x16_bf16 v[168:183], v[188:191], v[84:87], v[168:183]
    ds_read_b128 v[220:223], v13 offset:23552
    v_mul_f32 v228, v228, v236
    v_mul_f32 v229, v229, v237
    v_mul_f32 v230, v230, v238
    v_mul_f32 v231, v231, v239
    v_fma_f32 v240, v240, v17, v17
    s_waitcnt lgkmcnt(4)
    s_nop 0
    v_mfma_f32_32x32x16_bf16 v[168:183], v[192:195], v[88:91], v[168:183]
    ds_read_b128 v[184:187], v13 offset:24576
    v_fma_f32 v241, v241, v17, v17
    v_fma_f32 v242, v242, v17, v17
    v_fma_f32 v243, v243, v17, v17
    v_fma_f32 v244, v244, v17, v17
    v_mfma_f32_32x32x16_bf16 v[168:183], v[196:199], v[92:95], v[168:183]
    ds_read_b128 v[188:191], v13 offset:25600
    buffer_load_dwordx4 v6, s[32:35], s100 offen offset:1024 sc1 lds
    v_fma_f32 v245, v245, v17, v17
    v_fma_f32 v246, v246, v17, v17
    v_fma_f32 v247, v247, v17, v17
    s_waitcnt vmcnt(6)
    s_barrier
    v_mfma_f32_32x32x16_bf16 v[168:183], v[200:203], v[96:99], v[168:183]
    ds_read_b128 v[192:195], v13 offset:26624
    v_rcp_f32 v240, v240
    v_rcp_f32 v241, v241
    v_mfma_f32_32x32x16_bf16 v[168:183], v[204:207], v[100:103], v[168:183]
    ds_read_b128 v[196:199], v13 offset:27648
    v_rcp_f32 v242, v242
    v_rcp_f32_e64 v243, v243
    s_waitcnt lgkmcnt(4)
    v_mfma_f32_32x32x16_bf16 v[168:183], v[208:211], v[104:107], v[168:183]
    v_add_u32 v14, 86016, v6
    ds_read_b128 v[200:203], v14 offset:0
    buffer_load_dwordx4 v6, s[32:35], s100 offen offset:2048 sc1 lds
    v_mfma_f32_32x32x16_bf16 v[168:183], v[212:215], v[108:111], v[168:183]
    ds_read_b128 v[204:207], v14 offset:1024
    v_rcp_f32 v244, v244
    v_rcp_f32 v245, v245
    v_mfma_f32_32x32x16_bf16 v[168:183], v[216:219], v[112:115], v[168:183]
    ds_read_b128 v[208:211], v14 offset:2048
    v_rcp_f32 v246, v246
    v_rcp_f32 v247, v247
    v_mul_f32_e64 v224, v224, v240
    v_mfma_f32_32x32x16_bf16 v[168:183], v[220:223], v[116:119], v[168:183]
    ds_read_b128 v[212:215], v14 offset:3072
    s_add_u32 m0, s89, 28672
    s_add_u32 s100, s60, 172032
    buffer_load_dwordx4 v6, s[32:35], s100 offen offset:0 sc1 lds
    v_mul_f32 v225, v225, v241
    s_waitcnt lgkmcnt(4)
    v_mfma_f32_32x32x16_bf16 v[168:183], v[184:187], v[120:123], v[168:183]
    ds_read_b128 v[216:219], v14 offset:4096
    v_mul_f32 v226, v226, v242
    v_mul_f32 v227, v227, v243
    v_mul_f32 v228, v228, v244
    v_mul_f32 v229, v229, v245
    v_mfma_f32_32x32x16_bf16 v[168:183], v[188:191], v[124:127], v[168:183]
    ds_read_b128 v[220:223], v14 offset:5120
    v_mul_f32 v230, v230, v246
    v_mul_f32 v231, v231, v247
    v_cvt_pk_bf16_f32 v248, v224, v225
    v_cvt_pk_bf16_f32 v249, v226, v227
    v_cvt_pk_bf16_f32 v250, v228, v229
    v_mfma_f32_32x32x16_bf16 v[168:183], v[192:195], v[128:131], v[168:183]
    ds_read_b128 v[184:187], v14 offset:6144
    buffer_load_dwordx4 v6, s[32:35], s100 offen offset:1024 sc1 lds
    v_cvt_pk_bf16_f32 v251, v230, v231
    s_add_u32 s50, s95, 0
    s_nop 0
    v_mfma_f32_32x32x16_bf16 v[168:183], v[196:199], v[132:135], v[168:183]
    ds_read_b128 v[188:191], v14 offset:7168
    buffer_store_dwordx4 v[248:251], v6, s[32:35], s50 offen sc1
    ds_read_b128 v[224:227], v12 offset:128
    ds_read_b128 v[228:231], v12 offset:160
    ds_read_b128 v[232:235], v12 offset:192
    s_waitcnt lgkmcnt(7)
    s_nop 0
    v_mfma_f32_32x32x16_bf16 v[136:151], v[200:203], v[24:27], 0
    ds_read_b128 v[192:195], v14 offset:8192
    ds_read_b128 v[236:239], v12 offset:224
    v_mfma_f32_32x32x16_bf16 v[136:151], v[204:207], v[28:31], v[136:151]
    ds_read_b128 v[196:199], v14 offset:9216
    buffer_load_dwordx4 v6, s[32:35], s100 offen offset:2048 sc1 lds
    v_mfma_f32_32x32x16_bf16 v[136:151], v[208:211], v[32:35], v[136:151]
    ds_read_b128 v[200:203], v14 offset:10240
    v_mfma_f32_32x32x16_bf16 v[136:151], v[212:215], v[36:39], v[136:151]
    ds_read_b128 v[204:207], v14 offset:11264
    s_waitcnt lgkmcnt(7)
    v_fma_f32 v224, v15, v224, v152
    v_fma_f32 v225, v15, v225, v153
    v_fma_f32 v226, v15, v226, v154
    v_fma_f32 v227, v15, v227, v155
    s_waitcnt lgkmcnt(6)
    v_fma_f32 v228, v15, v228, v156
    v_mfma_f32_32x32x16_bf16 v[136:151], v[216:219], v[40:43], v[136:151]
    ds_read_b128 v[208:211], v14 offset:12288
    buffer_load_dwordx4 v6, s[32:35], s100 offen offset:3072 sc1 lds
    v_fma_f32 v229, v15, v229, v157
    v_fma_f32 v230, v15, v230, v158
    v_mfma_f32_32x32x16_bf16 v[136:151], v[220:223], v[44:47], v[136:151]
    ds_read_b128 v[212:215], v14 offset:13312
    v_fma_f32 v231, v15, v231, v159
    s_waitcnt lgkmcnt(7)
    s_nop 0
    v_fma_f32 v232, v15, v232, v160
    v_fma_f32 v233, v15, v233, v161
    v_fma_f32 v234, v15, v234, v162
    v_fma_f32 v235, v15, v235, v163
    v_mfma_f32_32x32x16_bf16 v[136:151], v[184:187], v[48:51], v[136:151]
    ds_read_b128 v[216:219], v14 offset:14336
    s_waitcnt lgkmcnt(6)
    v_fma_f32 v236, v15, v236, v164
    v_fma_f32 v237, v15, v237, v165
    v_fma_f32 v238, v15, v238, v166
    v_fma_f32 v239, v15, v239, v167
    v_mul_f32 v240, v224, v16
    v_mfma_f32_32x32x16_bf16 v[136:151], v[188:191], v[52:55], v[136:151]
    ds_read_b128 v[220:223], v14 offset:15360
    s_add_u32 m0, s89, 32768
    s_add_u32 s100, s60, 176128
    buffer_load_dwordx4 v6, s[32:35], s100 offen offset:0 sc1 lds
    v_mul_f32 v241, v225, v16
    s_waitcnt lgkmcnt(4)
    v_mfma_f32_32x32x16_bf16 v[136:151], v[192:195], v[56:59], v[136:151]
    ds_read_b128 v[184:187], v14 offset:16384
    v_mul_f32 v242, v226, v16
    v_mul_f32 v243, v227, v16
    v_mul_f32 v244, v228, v16
    v_mul_f32 v245, v229, v16
    v_mfma_f32_32x32x16_bf16 v[136:151], v[196:199], v[60:63], v[136:151]
    ds_read_b128 v[188:191], v14 offset:17408
    v_mul_f32 v246, v230, v16
    v_mul_f32 v247, v231, v16
    v_exp_f32_e64 v240, v240
    v_mfma_f32_32x32x16_bf16 v[136:151], v[200:203], v[64:67], v[136:151]
    ds_read_b128 v[192:195], v14 offset:18432
    buffer_load_dwordx4 v6, s[32:35], s100 offen offset:1024 sc1 lds
    v_exp_f32_e64 v241, v241
    v_mfma_f32_32x32x16_bf16 v[136:151], v[204:207], v[68:71], v[136:151]
    ds_read_b128 v[196:199], v14 offset:19456
    v_exp_f32 v242, v242
    v_exp_f32_e64 v243, v243
    s_waitcnt lgkmcnt(4)
    v_mfma_f32_32x32x16_bf16 v[136:151], v[208:211], v[72:75], v[136:151]
    ds_read_b128 v[200:203], v14 offset:20480
    v_exp_f32 v244, v244
    v_exp_f32 v245, v245
    v_mfma_f32_32x32x16_bf16 v[136:151], v[212:215], v[76:79], v[136:151]
    ds_read_b128 v[204:207], v14 offset:21504
    buffer_load_dwordx4 v6, s[32:35], s100 offen offset:2048 sc1 lds
    v_exp_f32_e64 v246, v246
    v_mfma_f32_32x32x16_bf16 v[136:151], v[216:219], v[80:83], v[136:151]
    ds_read_b128 v[208:211], v14 offset:22528
    v_exp_f32 v247, v247
    v_mul_f32 v224, v224, v232
    v_mul_f32 v225, v225, v233
    v_mul_f32 v226, v226, v234
    v_mfma_f32_32x32x16_bf16 v[136:151], v[220:223], v[84:87], v[136:151]
    ds_read_b128 v[212:215], v14 offset:23552
    v_mul_f32 v227, v227, v235
    v_mul_f32 v228, v228, v236
    v_mul_f32 v229, v229, v237
    v_mul_f32 v230, v230, v238
    v_mul_f32 v231, v231, v239
    s_waitcnt lgkmcnt(4)
    v_mfma_f32_32x32x16_bf16 v[136:151], v[184:187], v[88:91], v[136:151]
    ds_read_b128 v[216:219], v14 offset:24576
    s_add_u32 s101, s81, 24576
    buffer_load_dwordx4 a[96:99], v6, s[32:35], s101 offen offset:0 sc1
    v_fma_f32 v240, v240, v17, v17
    v_mfma_f32_32x32x16_bf16 v[136:151], v[188:191], v[92:95], v[136:151]
    ds_read_b128 v[220:223], v14 offset:25600
    v_fma_f32 v241, v241, v17, v17
    v_fma_f32 v242, v242, v17, v17
    v_fma_f32 v243, v243, v17, v17
    v_fma_f32 v244, v244, v17, v17
    v_fma_f32 v245, v245, v17, v17
    v_mfma_f32_32x32x16_bf16 v[136:151], v[192:195], v[96:99], v[136:151]
    ds_read_b128 v[184:187], v14 offset:26624
    v_fma_f32 v246, v246, v17, v17
    v_fma_f32 v247, v247, v17, v17
    v_rcp_f32_e64 v240, v240
    v_mfma_f32_32x32x16_bf16 v[136:151], v[196:199], v[100:103], v[136:151]
    ds_read_b128 v[188:191], v14 offset:27648
    buffer_load_dwordx4 a[100:103], v6, s[32:35], s101 offen offset:1024 sc1
    v_rcp_f32 v241, v241
    s_waitcnt lgkmcnt(4)
    v_mfma_f32_32x32x16_bf16 v[136:151], v[200:203], v[104:107], v[136:151]
    v_add_u32 v13, 114688, v6
    ds_read_b128 v[192:195], v13 offset:0
    v_rcp_f32_e64 v242, v242
    v_mfma_f32_32x32x16_bf16 v[136:151], v[204:207], v[108:111], v[136:151]
    ds_read_b128 v[196:199], v13 offset:1024
    v_rcp_f32 v243, v243
    v_rcp_f32 v244, v244
    v_mfma_f32_32x32x16_bf16 v[136:151], v[208:211], v[112:115], v[136:151]
    ds_read_b128 v[200:203], v13 offset:2048
    buffer_load_dwordx4 a[104:107], v6, s[32:35], s101 offen offset:2048 sc1
    v_rcp_f32_e64 v245, v245
    v_mfma_f32_32x32x16_bf16 v[136:151], v[212:215], v[116:119], v[136:151]
    ds_read_b128 v[204:207], v13 offset:3072
    v_rcp_f32 v246, v246
    v_rcp_f32 v247, v247
    v_mul_f32 v224, v224, v240
    s_waitcnt lgkmcnt(4)
    v_mfma_f32_32x32x16_bf16 v[136:151], v[216:219], v[120:123], v[136:151]
    ds_read_b128 v[208:211], v13 offset:4096
    v_mul_f32 v225, v225, v241
    v_mul_f32 v226, v226, v242
    v_mul_f32 v227, v227, v243
    v_mul_f32 v228, v228, v244
    v_mfma_f32_32x32x16_bf16 v[136:151], v[220:223], v[124:127], v[136:151]
    ds_read_b128 v[212:215], v13 offset:5120
    buffer_load_dwordx4 a[108:111], v6, s[32:35], s101 offen offset:3072 sc1
    v_mul_f32 v229, v229, v245
    v_mul_f32 v230, v230, v246
    v_mul_f32_e64 v231, v231, v247
    v_mfma_f32_32x32x16_bf16 v[136:151], v[184:187], v[128:131], v[136:151]
    ds_read_b128 v[216:219], v13 offset:6144
    v_cvt_pk_bf16_f32 v248, v224, v225
    v_cvt_pk_bf16_f32 v249, v226, v227
    v_cvt_pk_bf16_f32 v250, v228, v229
    v_cvt_pk_bf16_f32 v251, v230, v231
    s_add_u32 s50, s95, 8192
    v_mfma_f32_32x32x16_bf16 v[136:151], v[188:191], v[132:135], v[136:151]
    ds_read_b128 v[220:223], v13 offset:7168
    buffer_store_dwordx4 v[248:251], v6, s[32:35], s50 offen sc1
    ds_read_b128 v[224:227], v12 offset:256
    ds_read_b128 v[228:231], v12 offset:288
    ds_read_b128 v[232:235], v12 offset:320
    s_waitcnt lgkmcnt(7)
    s_nop 0
    v_mfma_f32_32x32x16_bf16 v[152:167], v[192:195], v[24:27], 0
    ds_read_b128 v[184:187], v13 offset:8192
    s_add_u32 s101, s81, 28672
    buffer_load_dwordx4 a[112:115], v6, s[32:35], s101 offen offset:0 sc1
    ds_read_b128 v[236:239], v12 offset:352
    v_mfma_f32_32x32x16_bf16 v[152:167], v[196:199], v[28:31], v[152:167]
    ds_read_b128 v[188:191], v13 offset:9216
    v_mfma_f32_32x32x16_bf16 v[152:167], v[200:203], v[32:35], v[152:167]
    ds_read_b128 v[192:195], v13 offset:10240
    v_mfma_f32_32x32x16_bf16 v[152:167], v[204:207], v[36:39], v[152:167]
    ds_read_b128 v[196:199], v13 offset:11264
    buffer_load_dwordx4 a[116:119], v6, s[32:35], s101 offen offset:1024 sc1
    s_waitcnt lgkmcnt(7)
    s_nop 0
    v_fma_f32 v224, v15, v224, v168
    v_fma_f32 v225, v15, v225, v169
    v_fma_f32 v226, v15, v226, v170
    v_mfma_f32_32x32x16_bf16 v[152:167], v[208:211], v[40:43], v[152:167]
    ds_read_b128 v[200:203], v13 offset:12288
    v_fma_f32 v227, v15, v227, v171
    s_waitcnt lgkmcnt(7)
    s_nop 0
    v_fma_f32 v228, v15, v228, v172
    v_fma_f32 v229, v15, v229, v173
    v_fma_f32 v230, v15, v230, v174
    v_mfma_f32_32x32x16_bf16 v[152:167], v[212:215], v[44:47], v[152:167]
    ds_read_b128 v[204:207], v13 offset:13312
    v_fma_f32 v231, v15, v231, v175
    s_waitcnt lgkmcnt(7)
    s_nop 0
    v_fma_f32 v232, v15, v232, v176
    v_fma_f32 v233, v15, v233, v177
    v_fma_f32 v234, v15, v234, v178
    v_fma_f32 v235, v15, v235, v179
    v_mfma_f32_32x32x16_bf16 v[152:167], v[216:219], v[48:51], v[152:167]
    ds_read_b128 v[208:211], v13 offset:14336
    buffer_load_dwordx4 a[120:123], v6, s[32:35], s101 offen offset:2048 sc1
    s_waitcnt lgkmcnt(6)
    s_nop 0
    v_fma_f32 v236, v15, v236, v180
    v_fma_f32 v237, v15, v237, v181
    v_fma_f32 v238, v15, v238, v182
    v_mfma_f32_32x32x16_bf16 v[152:167], v[220:223], v[52:55], v[152:167]
    ds_read_b128 v[212:215], v13 offset:15360
    v_fma_f32 v239, v15, v239, v183
    v_mul_f32 v240, v224, v16
    v_mul_f32 v241, v225, v16
    v_mul_f32 v242, v226, v16
    v_mul_f32_e64 v243, v227, v16
    s_waitcnt lgkmcnt(4)
    v_mfma_f32_32x32x16_bf16 v[152:167], v[184:187], v[56:59], v[152:167]
    ds_read_b128 v[216:219], v13 offset:16384
    v_mul_f32 v244, v228, v16
    v_mul_f32 v245, v229, v16
    v_mul_f32 v246, v230, v16
    v_mul_f32 v247, v231, v16
    v_mfma_f32_32x32x16_bf16 v[152:167], v[188:191], v[60:63], v[152:167]
    ds_read_b128 v[220:223], v13 offset:17408
    buffer_load_dwordx4 a[124:127], v6, s[32:35], s101 offen offset:3072 sc1
    v_exp_f32_e64 v240, v240
    v_mfma_f32_32x32x16_bf16 v[152:167], v[192:195], v[64:67], v[152:167]
    ds_read_b128 v[184:187], v13 offset:18432
    v_exp_f32 v241, v241
    v_exp_f32 v242, v242
    v_mfma_f32_32x32x16_bf16 v[152:167], v[196:199], v[68:71], v[152:167]
    ds_read_b128 v[188:191], v13 offset:19456
    v_exp_f32 v243, v243
    v_exp_f32_e64 v244, v244
    s_waitcnt lgkmcnt(4)
    v_mfma_f32_32x32x16_bf16 v[152:167], v[200:203], v[72:75], v[152:167]
    ds_read_b128 v[192:195], v13 offset:20480
    s_add_u32 s101, s81, 32768
    buffer_load_dwordx4 a[128:131], v6, s[32:35], s101 offen offset:0 sc1
    v_mfma_f32_32x32x16_bf16 v[152:167], v[204:207], v[76:79], v[152:167]
    ds_read_b128 v[196:199], v13 offset:21504
    v_exp_f32 v245, v245
    v_exp_f32 v246, v246
    v_mfma_f32_32x32x16_bf16 v[152:167], v[208:211], v[80:83], v[152:167]
    ds_read_b128 v[200:203], v13 offset:22528
    v_exp_f32 v247, v247
    v_mul_f32 v224, v224, v232
    v_mul_f32 v225, v225, v233
    v_mul_f32 v226, v226, v234
    v_mfma_f32_32x32x16_bf16 v[152:167], v[212:215], v[84:87], v[152:167]
    ds_read_b128 v[204:207], v13 offset:23552
    buffer_load_dwordx4 a[132:135], v6, s[32:35], s101 offen offset:1024 sc1
    v_mul_f32 v227, v227, v235
    v_mul_f32 v228, v228, v236
    v_mul_f32 v229, v229, v237
    s_waitcnt lgkmcnt(4)
    v_mfma_f32_32x32x16_bf16 v[152:167], v[216:219], v[88:91], v[152:167]
    ds_read_b128 v[208:211], v13 offset:24576
    v_mul_f32 v230, v230, v238
    v_mul_f32 v231, v231, v239
    v_fma_f32 v240, v240, v17, v17
    v_fma_f32 v241, v241, v17, v17
    v_mfma_f32_32x32x16_bf16 v[152:167], v[220:223], v[92:95], v[152:167]
    ds_read_b128 v[212:215], v13 offset:25600
    v_fma_f32 v242, v242, v17, v17
    v_fma_f32 v243, v243, v17, v17
    v_fma_f32 v244, v244, v17, v17
    v_fma_f32 v245, v245, v17, v17
    v_fma_f32 v246, v246, v17, v17
    s_waitcnt vmcnt(11)
    s_waitcnt vmcnt(6)
    s_barrier
    s_cmp_lg_u32 s48, 3
    s_cbranch_scc1 sig_38
    s_mov_b64 exec, 1
    buffer_atomic_add v4, v5, s[32:35], s96 offen sc1
    s_mov_b64 exec, -1
sig_38:
    v_mfma_f32_32x32x16_bf16 v[152:167], v[184:187], v[96:99], v[152:167]
    ds_read_b128 v[216:219], v13 offset:26624
    buffer_load_dwordx4 a[136:139], v6, s[32:35], s101 offen offset:2048 sc1
    v_fma_f32 v247, v247, v17, v17
    v_rcp_f32 v240, v240
    v_mfma_f32_32x32x16_bf16 v[152:167], v[188:191], v[100:103], v[152:167]
    ds_read_b128 v[220:223], v13 offset:27648
    v_rcp_f32 v241, v241
    v_rcp_f32_e64 v242, v242
    s_waitcnt lgkmcnt(4)
    v_mfma_f32_32x32x16_bf16 v[152:167], v[192:195], v[104:107], v[152:167]
    v_add_u32_e64 v14, 0, v6
    ds_read_b128 v[184:187], v14 offset:0
    v_rcp_f32_e64 v243, v243
    v_mfma_f32_32x32x16_bf16 v[152:167], v[196:199], v[108:111], v[152:167]
    ds_read_b128 v[188:191], v14 offset:1024
    buffer_load_dwordx4 a[140:143], v6, s[32:35], s101 offen offset:3072 sc1
    v_rcp_f32_e64 v244, v244
    v_mfma_f32_32x32x16_bf16 v[152:167], v[200:203], v[112:115], v[152:167]
    ds_read_b128 v[192:195], v14 offset:2048
    v_rcp_f32 v245, v245
    v_rcp_f32 v246, v246
    v_mfma_f32_32x32x16_bf16 v[152:167], v[204:207], v[116:119], v[152:167]
    ds_read_b128 v[196:199], v14 offset:3072
    v_rcp_f32 v247, v247
    v_mul_f32 v224, v224, v240
    v_mul_f32 v225, v225, v241
    v_mul_f32_e64 v226, v226, v242
    s_waitcnt lgkmcnt(4)
    v_mfma_f32_32x32x16_bf16 v[152:167], v[208:211], v[120:123], v[152:167]
    ds_read_b128 v[200:203], v14 offset:4096
    s_add_u32 s101, s81, 36864
    buffer_load_dwordx4 a[144:147], v6, s[32:35], s101 offen offset:0 sc1
    v_mul_f32_e64 v227, v227, v243
    v_mfma_f32_32x32x16_bf16 v[152:167], v[212:215], v[124:127], v[152:167]
    ds_read_b128 v[204:207], v14 offset:5120
    v_mul_f32 v228, v228, v244
    v_mul_f32 v229, v229, v245
    v_mul_f32 v230, v230, v246
    v_mul_f32 v231, v231, v247
    v_cvt_pk_bf16_f32 v248, v224, v225
    v_mfma_f32_32x32x16_bf16 v[152:167], v[216:219], v[128:131], v[152:167]
    ds_read_b128 v[208:211], v14 offset:6144
    v_cvt_pk_bf16_f32 v249, v226, v227
    v_cvt_pk_bf16_f32 v250, v228, v229
    v_cvt_pk_bf16_f32 v251, v230, v231
    s_add_u32 s50, s95, 16384
    v_mfma_f32_32x32x16_bf16 v[152:167], v[220:223], v[132:135], v[152:167]
    ds_read_b128 v[212:215], v14 offset:7168
    buffer_load_dwordx4 a[148:151], v6, s[32:35], s101 offen offset:1024 sc1
    buffer_store_dwordx4 v[248:251], v6, s[32:35], s50 offen sc1
    ds_read_b128 v[224:227], v12 offset:384
    s_waitcnt lgkmcnt(5)
    s_nop 0
    v_mfma_f32_32x32x16_bf16 v[168:183], v[184:187], v[24:27], 0
    ds_read_b128 v[216:219], v14 offset:8192
    ds_read_b128 v[228:231], v12 offset:416
    ds_read_b128 v[232:235], v12 offset:448
    ds_read_b128 v[236:239], v12 offset:480
    v_mfma_f32_32x32x16_bf16 v[168:183], v[188:191], v[28:31], v[168:183]
    ds_read_b128 v[220:223], v14 offset:9216
    v_mfma_f32_32x32x16_bf16 v[168:183], v[192:195], v[32:35], v[168:183]
    ds_read_b128 v[184:187], v14 offset:10240
    buffer_load_dwordx4 a[152:155], v6, s[32:35], s101 offen offset:2048 sc1
    v_mfma_f32_32x32x16_bf16 v[168:183], v[196:199], v[36:39], v[168:183]
    ds_read_b128 v[188:191], v14 offset:11264
    s_waitcnt lgkmcnt(7)
    v_fma_f32 v224, v15, v224, v136
    v_fma_f32 v225, v15, v225, v137
    v_fma_f32 v226, v15, v226, v138
    v_fma_f32 v227, v15, v227, v139
    s_waitcnt lgkmcnt(5)
    v_fma_f32 v228, v15, v228, v140
    v_mfma_f32_32x32x16_bf16 v[168:183], v[200:203], v[40:43], v[168:183]
    ds_read_b128 v[192:195], v14 offset:12288
    v_fma_f32 v229, v15, v229, v141
    v_fma_f32 v230, v15, v230, v142
    v_fma_f32 v231, v15, v231, v143
    s_waitcnt lgkmcnt(5)
    s_nop 0
    v_fma_f32 v232, v15, v232, v144
    v_mfma_f32_32x32x16_bf16 v[168:183], v[204:207], v[44:47], v[168:183]
    ds_read_b128 v[196:199], v14 offset:13312
    buffer_load_dwordx4 a[156:159], v6, s[32:35], s101 offen offset:3072 sc1
    v_fma_f32 v233, v15, v233, v145
    v_fma_f32 v234, v15, v234, v146
    v_fma_f32 v235, v15, v235, v147
    v_mfma_f32_32x32x16_bf16 v[168:183], v[208:211], v[48:51], v[168:183]
    ds_read_b128 v[200:203], v14 offset:14336
    s_waitcnt lgkmcnt(6)
    v_fma_f32 v236, v15, v236, v148
    v_fma_f32 v237, v15, v237, v149
    v_fma_f32 v238, v15, v238, v150
    v_fma_f32 v239, v15, v239, v151
    v_mul_f32 v240, v224, v16
    v_mfma_f32_32x32x16_bf16 v[168:183], v[212:215], v[52:55], v[168:183]
    ds_read_b128 v[204:207], v14 offset:15360
    v_mul_f32 v241, v225, v16
    v_mul_f32 v242, v226, v16
    v_mul_f32 v243, v227, v16
    v_mul_f32 v244, v228, v16
    v_mul_f32 v245, v229, v16
    s_waitcnt lgkmcnt(4)
    v_mfma_f32_32x32x16_bf16 v[168:183], v[216:219], v[56:59], v[168:183]
    ds_read_b128 v[208:211], v14 offset:16384
    s_add_u32 s101, s81, 40960
    buffer_load_dwordx4 a[160:163], v6, s[32:35], s101 offen offset:0 sc1
    v_mul_f32_e64 v246, v230, v16
    v_mfma_f32_32x32x16_bf16 v[168:183], v[220:223], v[60:63], v[168:183]
    ds_read_b128 v[212:215], v14 offset:17408
    v_mul_f32 v247, v231, v16
    v_exp_f32 v240, v240
    v_exp_f32_e64 v241, v241
    v_mfma_f32_32x32x16_bf16 v[168:183], v[184:187], v[64:67], v[168:183]
    ds_read_b128 v[216:219], v14 offset:18432
    v_exp_f32 v242, v242
    v_exp_f32 v243, v243
    v_mfma_f32_32x32x16_bf16 v[168:183], v[188:191], v[68:71], v[168:183]
    ds_read_b128 v[220:223], v14 offset:19456
    buffer_load_dwordx4 a[164:167], v6, s[32:35], s101 offen offset:1024 sc1
    v_exp_f32 v244, v244
    s_waitcnt lgkmcnt(4)
    v_mfma_f32_32x32x16_bf16 v[168:183], v[192:195], v[72:75], v[168:183]
    ds_read_b128 v[184:187], v14 offset:20480
    v_exp_f32 v245, v245
    v_exp_f32 v246, v246
    v_mfma_f32_32x32x16_bf16 v[168:183], v[196:199], v[76:79], v[168:183]
    ds_read_b128 v[188:191], v14 offset:21504
    v_exp_f32 v247, v247
    v_mul_f32 v224, v224, v232
    v_mul_f32 v225, v225, v233
    v_mul_f32 v226, v226, v234
    v_mfma_f32_32x32x16_bf16 v[168:183], v[200:203], v[80:83], v[168:183]
    ds_read_b128 v[192:195], v14 offset:22528
    buffer_load_dwordx4 a[168:171], v6, s[32:35], s101 offen offset:2048 sc1
    v_mul_f32 v227, v227, v235
    v_mul_f32 v228, v228, v236
    v_mul_f32_e64 v229, v229, v237
    v_mfma_f32_32x32x16_bf16 v[168:183], v[204:207], v[84:87], v[168:183]
    ds_read_b128 v[196:199], v14 offset:23552
    v_mul_f32 v230, v230, v238
    v_mul_f32 v231, v231, v239
    v_fma_f32 v240, v240, v17, v17
    v_fma_f32 v241, v241, v17, v17
    v_fma_f32 v242, v242, v17, v17
    s_waitcnt lgkmcnt(4)
    s_nop 0
    v_mfma_f32_32x32x16_bf16 v[168:183], v[208:211], v[88:91], v[168:183]
    ds_read_b128 v[200:203], v14 offset:24576
    v_fma_f32 v243, v243, v17, v17
    v_fma_f32 v244, v244, v17, v17
    v_fma_f32 v245, v245, v17, v17
    v_fma_f32 v246, v246, v17, v17
    v_mfma_f32_32x32x16_bf16 v[168:183], v[212:215], v[92:95], v[168:183]
    ds_read_b128 v[204:207], v14 offset:25600
    buffer_load_dwordx4 a[172:175], v6, s[32:35], s101 offen offset:3072 sc1
    v_fma_f32 v247, v247, v17, v17
    v_rcp_f32_e64 v240, v240
    v_mfma_f32_32x32x16_bf16 v[168:183], v[216:219], v[96:99], v[168:183]
    ds_read_b128 v[208:211], v14 offset:26624
    v_rcp_f32 v241, v241
    v_rcp_f32 v242, v242
    v_mfma_f32_32x32x16_bf16 v[168:183], v[220:223], v[100:103], v[168:183]
    ds_read_b128 v[212:215], v14 offset:27648
    v_rcp_f32 v243, v243
    v_rcp_f32_e64 v244, v244
    s_waitcnt lgkmcnt(4)
    v_mfma_f32_32x32x16_bf16 v[168:183], v[184:187], v[104:107], v[168:183]
    v_add_u32 v13, 28672, v6
    ds_read_b128 v[216:219], v13 offset:0
    s_add_u32 s101, s81, 45056
    buffer_load_dwordx4 a[176:179], v6, s[32:35], s101 offen offset:0 sc1
    v_mfma_f32_32x32x16_bf16 v[168:183], v[188:191], v[108:111], v[168:183]
    ds_read_b128 v[220:223], v13 offset:1024
    v_rcp_f32 v245, v245
    v_rcp_f32 v246, v246
    v_mfma_f32_32x32x16_bf16 v[168:183], v[192:195], v[112:115], v[168:183]
    ds_read_b128 v[184:187], v13 offset:2048
    v_rcp_f32 v247, v247
    v_mul_f32 v224, v224, v240
    v_mul_f32 v225, v225, v241
    v_mul_f32 v226, v226, v242
    v_mfma_f32_32x32x16_bf16 v[168:183], v[196:199], v[116:119], v[168:183]
    ds_read_b128 v[188:191], v13 offset:3072
    buffer_load_dwordx4 a[180:183], v6, s[32:35], s101 offen offset:1024 sc1
    v_mul_f32 v227, v227, v243
    v_mul_f32 v228, v228, v244
    v_mul_f32 v229, v229, v245
    s_waitcnt lgkmcnt(4)
    v_mfma_f32_32x32x16_bf16 v[168:183], v[200:203], v[120:123], v[168:183]
    ds_read_b128 v[192:195], v13 offset:4096
    v_mul_f32 v230, v230, v246
    v_mul_f32 v231, v231, v247
    v_cvt_pk_bf16_f32 v248, v224, v225
    v_cvt_pk_bf16_f32 v249, v226, v227
    v_mfma_f32_32x32x16_bf16 v[168:183], v[204:207], v[124:127], v[168:183]
    ds_read_b128 v[196:199], v13 offset:5120
    v_cvt_pk_bf16_f32 v250, v228, v229
    v_cvt_pk_bf16_f32 v251, v230, v231
    s_add_u32 s50, s95, 24576
    buffer_store_dwordx4 v[248:251], v6, s[32:35], s50 offen sc1
    v_mfma_f32_32x32x16_bf16 v[168:183], v[208:211], v[128:131], v[168:183]
    ds_read_b128 v[200:203], v13 offset:6144
    buffer_load_dwordx4 a[184:187], v6, s[32:35], s101 offen offset:2048 sc1
    ds_read_b128 v[224:227], v12 offset:512
    ds_read_b128 v[228:231], v12 offset:544
    ds_read_b128 v[232:235], v12 offset:576
    v_mfma_f32_32x32x16_bf16 v[168:183], v[212:215], v[132:135], v[168:183]
    ds_read_b128 v[204:207], v13 offset:7168
    ds_read_b128 v[236:239], v12 offset:608
    s_waitcnt lgkmcnt(8)
    s_nop 0
    v_mfma_f32_32x32x16_bf16 v[136:151], v[216:219], v[24:27], 0
    ds_read_b128 v[208:211], v13 offset:8192
    v_mfma_f32_32x32x16_bf16 v[136:151], v[220:223], v[28:31], v[136:151]
    ds_read_b128 v[212:215], v13 offset:9216
    buffer_load_dwordx4 a[188:191], v6, s[32:35], s101 offen offset:3072 sc1
    v_mfma_f32_32x32x16_bf16 v[136:151], v[184:187], v[32:35], v[136:151]
    ds_read_b128 v[216:219], v13 offset:10240
    s_waitcnt lgkmcnt(7)
    v_fma_f32 v224, v15, v224, v152
    v_fma_f32 v225, v15, v225, v153
    v_fma_f32 v226, v15, v226, v154
    v_fma_f32 v227, v15, v227, v155
    s_waitcnt lgkmcnt(6)
    v_fma_f32 v228, v15, v228, v156
    v_mfma_f32_32x32x16_bf16 v[136:151], v[188:191], v[36:39], v[136:151]
    ds_read_b128 v[220:223], v13 offset:11264
    v_fma_f32 v229, v15, v229, v157
    v_fma_f32 v230, v15, v230, v158
    v_fma_f32 v231, v15, v231, v159
    s_waitcnt lgkmcnt(6)
    v_fma_f32 v232, v15, v232, v160
    v_fma_f32 v233, v15, v233, v161
    s_waitcnt lgkmcnt(5)
    v_mfma_f32_32x32x16_bf16 v[136:151], v[192:195], v[40:43], v[136:151]
    ds_read_b128 v[184:187], v13 offset:12288
    s_add_u32 s101, s81, 49152
    buffer_load_dwordx4 a[192:195], v6, s[32:35], s101 offen offset:0 sc1
    v_fma_f32 v234, v15, v234, v162
    v_mfma_f32_32x32x16_bf16 v[136:151], v[196:199], v[44:47], v[136:151]
    ds_read_b128 v[188:191], v13 offset:13312
    v_fma_f32 v235, v15, v235, v163
    s_waitcnt lgkmcnt(6)
    s_nop 0
    v_fma_f32 v236, v15, v236, v164
    v_fma_f32 v237, v15, v237, v165
    v_fma_f32 v238, v15, v238, v166
    v_fma_f32 v239, v15, v239, v167
    v_mfma_f32_32x32x16_bf16 v[136:151], v[200:203], v[48:51], v[136:151]
    ds_read_b128 v[192:195], v13 offset:14336
    v_mul_f32 v240, v224, v16
    v_mul_f32 v241, v225, v16
    v_mul_f32 v242, v226, v16
    v_mul_f32 v243, v227, v16
    v_mul_f32_e64 v244, v228, v16
    v_mfma_f32_32x32x16_bf16 v[136:151], v[204:207], v[52:55], v[136:151]
    ds_read_b128 v[196:199], v13 offset:15360
    buffer_load_dwordx4 a[196:199], v6, s[32:35], s101 offen offset:1024 sc1
    v_mul_f32 v245, v229, v16
    v_mul_f32 v246, v230, v16
    v_mul_f32 v247, v231, v16
    s_waitcnt lgkmcnt(4)
    v_mfma_f32_32x32x16_bf16 v[136:151], v[208:211], v[56:59], v[136:151]
    ds_read_b128 v[200:203], v13 offset:16384
    v_exp_f32 v240, v240
    v_exp_f32 v241, v241
    v_mfma_f32_32x32x16_bf16 v[136:151], v[212:215], v[60:63], v[136:151]
    ds_read_b128 v[204:207], v13 offset:17408
    v_exp_f32 v242, v242
    v_exp_f32 v243, v243
    v_mfma_f32_32x32x16_bf16 v[136:151], v[216:219], v[64:67], v[136:151]
    ds_read_b128 v[208:211], v13 offset:18432
    buffer_load_dwordx4 a[200:203], v6, s[32:35], s101 offen offset:2048 sc1
    v_exp_f32_e64 v244, v244
    v_mfma_f32_32x32x16_bf16 v[136:151], v[220:223], v[68:71], v[136:151]
    ds_read_b128 v[212:215], v13 offset:19456
    v_exp_f32 v245, v245
    v_exp_f32_e64 v246, v246
    s_waitcnt lgkmcnt(4)
    v_mfma_f32_32x32x16_bf16 v[136:151], v[184:187], v[72:75], v[136:151]
    ds_read_b128 v[216:219], v13 offset:20480
    v_exp_f32 v247, v247
    v_mul_f32 v224, v224, v232
    v_mul_f32_e64 v225, v225, v233
    v_mfma_f32_32x32x16_bf16 v[136:151], v[188:191], v[76:79], v[136:151]
    ds_read_b128 v[220:223], v13 offset:21504
    buffer_load_dwordx4 a[204:207], v6, s[32:35], s101 offen offset:3072 sc1
    v_mul_f32 v226, v226, v234
    v_mul_f32 v227, v227, v235
    v_mul_f32_e64 v228, v228, v236
    v_mfma_f32_32x32x16_bf16 v[136:151], v[192:195], v[80:83], v[136:151]
    ds_read_b128 v[184:187], v13 offset:22528
    v_mul_f32 v229, v229, v237
    v_mul_f32 v230, v230, v238
    v_mul_f32_e64 v231, v231, v239
    v_fma_f32 v240, v240, v17, v17
    v_fma_f32 v241, v241, v17, v17
    v_mfma_f32_32x32x16_bf16 v[136:151], v[196:199], v[84:87], v[136:151]
    ds_read_b128 v[188:191], v13 offset:23552
    v_fma_f32 v242, v242, v17, v17
    v_fma_f32 v243, v243, v17, v17
    v_fma_f32 v244, v244, v17, v17
    v_fma_f32 v245, v245, v17, v17
    v_fma_f32 v246, v246, v17, v17
    s_waitcnt lgkmcnt(4)
    s_nop 0
    v_mfma_f32_32x32x16_bf16 v[136:151], v[200:203], v[88:91], v[136:151]
    ds_read_b128 v[192:195], v13 offset:24576
    s_add_u32 s101, s81, 53248
    buffer_load_dwordx4 a[208:211], v6, s[32:35], s101 offen offset:0 sc1
    v_fma_f32 v247, v247, v17, v17
    v_mfma_f32_32x32x16_bf16 v[136:151], v[204:207], v[92:95], v[136:151]
    ds_read_b128 v[196:199], v13 offset:25600
    v_rcp_f32 v240, v240
    v_rcp_f32 v241, v241
    v_mfma_f32_32x32x16_bf16 v[136:151], v[208:211], v[96:99], v[136:151]
    ds_read_b128 v[200:203], v13 offset:26624
    v_rcp_f32 v242, v242
    v_rcp_f32 v243, v243
    v_mfma_f32_32x32x16_bf16 v[136:151], v[212:215], v[100:103], v[136:151]
    ds_read_b128 v[204:207], v13 offset:27648
    buffer_load_dwordx4 a[212:215], v6, s[32:35], s101 offen offset:1024 sc1
    v_rcp_f32 v244, v244
    s_waitcnt lgkmcnt(4)
    v_mfma_f32_32x32x16_bf16 v[136:151], v[216:219], v[104:107], v[136:151]
    buffer_load_dword v19, v20, s[32:35], s98 offen sc1
    v_rcp_f32_e64 v245, v245
    v_mfma_f32_32x32x16_bf16 v[136:151], v[220:223], v[108:111], v[136:151]
    v_rcp_f32 v246, v246
    v_rcp_f32 v247, v247
    v_mul_f32 v224, v224, v240
    v_mul_f32 v225, v225, v241
    v_mfma_f32_32x32x16_bf16 v[136:151], v[184:187], v[112:115], v[136:151]
    buffer_load_dwordx4 a[216:219], v6, s[32:35], s101 offen offset:2048 sc1
    v_mul_f32 v226, v226, v242
    v_mul_f32 v227, v227, v243
    v_mul_f32 v228, v228, v244
    v_mul_f32 v229, v229, v245
    v_mfma_f32_32x32x16_bf16 v[136:151], v[188:191], v[116:119], v[136:151]
    v_mul_f32 v230, v230, v246
    v_mul_f32 v231, v231, v247
    v_cvt_pk_bf16_f32 v248, v224, v225
    v_cvt_pk_bf16_f32 v249, v226, v227
    v_cvt_pk_bf16_f32 v250, v228, v229
    v_cvt_pk_bf16_f32 v251, v230, v231
    s_waitcnt lgkmcnt(0)
    s_nop 0
    v_mfma_f32_32x32x16_bf16 v[136:151], v[192:195], v[120:123], v[136:151]
    s_add_u32 s50, s95, 32768
    buffer_store_dwordx4 v[248:251], v6, s[32:35], s50 offen sc1
    ds_read_b128 v[224:227], v12 offset:640
    ds_read_b128 v[228:231], v12 offset:672
    v_mfma_f32_32x32x16_bf16 v[136:151], v[196:199], v[124:127], v[136:151]
    buffer_load_dwordx4 a[220:223], v6, s[32:35], s101 offen offset:3072 sc1
    ds_read_b128 v[232:235], v12 offset:704
    ds_read_b128 v[236:239], v12 offset:736
    v_mfma_f32_32x32x16_bf16 v[136:151], v[200:203], v[128:131], v[136:151]
    v_mfma_f32_32x32x16_bf16 v[136:151], v[204:207], v[132:135], v[136:151]
    s_cmp_ge_u32 s2, 224
    s_cbranch_scc1 k_tail_2
    s_waitcnt vmcnt(3)
    v_cmp_ne_u32 vcc, 4, v19
    s_nop 0
    s_and_b32 s51, vcc_lo, 1
    s_cmp_eq_u32 s51, 0
    s_cbranch_scc1 polld_40
    s_mov_b32 s61, 0
poll_39:
    buffer_load_dword v19, v20, s[32:35], s98 offen sc1
    s_waitcnt vmcnt(0)
    v_cmp_ne_u32 vcc, 4, v19
    s_add_u32 s61, s61, 1
    s_cmp_gt_u32 s61, 32768
    s_cbranch_scc1 polld_40
    s_and_b32 s51, vcc_lo, 1
    s_cmp_eq_u32 s51, 0
    s_cbranch_scc1 polld_40
    s_sleep 2
    s_branch poll_39
polld_40:
    s_add_u32 s49, s82, 0
    buffer_load_dwordx4 v[24:27], v6, s[32:35], s49 offen offset:0 sc1
    buffer_load_dwordx4 v[28:31], v6, s[32:35], s49 offen offset:1024 sc1
    buffer_load_dwordx4 v[32:35], v6, s[32:35], s49 offen offset:2048 sc1
    buffer_load_dwordx4 v[36:39], v6, s[32:35], s49 offen offset:3072 sc1
    s_add_u32 s49, s82, 4096
    buffer_load_dwordx4 v[40:43], v6, s[32:35], s49 offen offset:0 sc1
    buffer_load_dwordx4 v[44:47], v6, s[32:35], s49 offen offset:1024 sc1
    buffer_load_dwordx4 v[48:51], v6, s[32:35], s49 offen offset:2048 sc1
    buffer_load_dwordx4 v[52:55], v6, s[32:35], s49 offen offset:3072 sc1
    s_add_u32 s49, s82, 8192
    buffer_load_dwordx4 v[56:59], v6, s[32:35], s49 offen offset:0 sc1
    buffer_load_dwordx4 v[60:63], v6, s[32:35], s49 offen offset:1024 sc1
    buffer_load_dwordx4 v[64:67], v6, s[32:35], s49 offen offset:2048 sc1
    buffer_load_dwordx4 v[68:71], v6, s[32:35], s49 offen offset:3072 sc1
    s_add_u32 s49, s82, 12288
    buffer_load_dwordx4 v[72:75], v6, s[32:35], s49 offen offset:0 sc1
    buffer_load_dwordx4 v[76:79], v6, s[32:35], s49 offen offset:1024 sc1
    buffer_load_dwordx4 v[80:83], v6, s[32:35], s49 offen offset:2048 sc1
    buffer_load_dwordx4 v[84:87], v6, s[32:35], s49 offen offset:3072 sc1
    s_lshl_b32 s49, s48, 3
    v_lshrrev_b32 v132, 3, v0
    v_add_u32 v132, s49, v132
    v_and_b32 v128, 7, v0
    v_mul_u32_u24 v131, 1056, v128
    v_lshl_add_u32 v131, v132, 4, v131
    v_mul_u32_u24 v129, 896, v132
    v_lshl_add_u32 v129, v128, 4, v129
    v_lshrrev_b32 v130, 1, v128
    v_lshlrev_b32 v130, 10, v130
    v_and_b32_e64 v128, 1, v128
    v_lshl_add_u32 v130, v128, 9, v130
    v_lshl_add_u32 v130, v132, 4, v130
    s_mul_i32 s50, s83, 57344
    s_lshl_b32 s51, s84, 12
    s_add_u32 s50, s50, s51
    s_add_u32 s50, s50, 7471104
    buffer_load_dwordx4 v[120:123], v130, s[32:35], s50 offen sc1
    s_add_u32 s50, s50, 28672
    buffer_load_dwordx4 v[124:127], v130, s[32:35], s50 offen sc1
    s_waitcnt lgkmcnt(3)
    v_fma_f32 v224, v15, v224, v168
    v_fma_f32 v225, v15, v225, v169
    v_fma_f32 v226, v15, v226, v170
    v_fma_f32 v227, v15, v227, v171
    s_waitcnt lgkmcnt(2)
    v_fma_f32 v228, v15, v228, v172
    v_fma_f32 v229, v15, v229, v173
    v_fma_f32 v230, v15, v230, v174
    v_fma_f32 v231, v15, v231, v175
    s_waitcnt lgkmcnt(1)
    v_fma_f32 v232, v15, v232, v176
    v_fma_f32 v233, v15, v233, v177
    v_fma_f32 v234, v15, v234, v178
    v_fma_f32 v235, v15, v235, v179
    s_waitcnt lgkmcnt(0)
    v_fma_f32 v236, v15, v236, v180
    v_fma_f32 v237, v15, v237, v181
    v_fma_f32 v238, v15, v238, v182
    v_fma_f32 v239, v15, v239, v183
    v_mul_f32 v240, v224, v16
    v_mul_f32 v241, v225, v16
    v_mul_f32 v242, v226, v16
    v_mul_f32 v243, v227, v16
    v_mul_f32 v244, v228, v16
    v_mul_f32 v245, v229, v16
    v_mul_f32 v246, v230, v16
    v_mul_f32 v247, v231, v16
    v_exp_f32 v240, v240
    v_exp_f32 v241, v241
    v_exp_f32 v242, v242
    v_exp_f32 v243, v243
    v_exp_f32 v244, v244
    v_exp_f32 v245, v245
    v_exp_f32 v246, v246
    v_exp_f32 v247, v247
    v_mul_f32 v224, v224, v232
    v_mul_f32 v225, v225, v233
    v_mul_f32 v226, v226, v234
    v_mul_f32 v227, v227, v235
    v_mul_f32 v228, v228, v236
    v_mul_f32 v229, v229, v237
    v_mul_f32 v230, v230, v238
    v_mul_f32 v231, v231, v239
    v_fma_f32 v240, v240, v17, v17
    v_fma_f32 v241, v241, v17, v17
    v_fma_f32 v242, v242, v17, v17
    v_fma_f32 v243, v243, v17, v17
    v_fma_f32 v244, v244, v17, v17
    v_fma_f32 v245, v245, v17, v17
    v_fma_f32 v246, v246, v17, v17
    v_fma_f32 v247, v247, v17, v17
    v_rcp_f32 v240, v240
    v_rcp_f32 v241, v241
    v_rcp_f32 v242, v242
    v_rcp_f32 v243, v243
    v_rcp_f32 v244, v244
    v_rcp_f32 v245, v245
    v_rcp_f32 v246, v246
    v_rcp_f32 v247, v247
    v_mul_f32 v224, v224, v240
    v_mul_f32 v225, v225, v241
    v_mul_f32 v226, v226, v242
    v_mul_f32 v227, v227, v243
    v_mul_f32 v228, v228, v244
    v_mul_f32 v229, v229, v245
    v_mul_f32 v230, v230, v246
    v_mul_f32 v231, v231, v247
    v_cvt_pk_bf16_f32 v248, v224, v225
    v_cvt_pk_bf16_f32 v249, v226, v227
    v_cvt_pk_bf16_f32 v250, v228, v229
    v_cvt_pk_bf16_f32 v251, v230, v231
    s_add_u32 s50, s95, 40960
    buffer_store_dwordx4 v[248:251], v6, s[32:35], s50 offen sc1
    ds_read_b128 v[224:227], v12 offset:768
    ds_read_b128 v[228:231], v12 offset:800
    ds_read_b128 v[232:235], v12 offset:832
    ds_read_b128 v[236:239], v12 offset:864
    s_waitcnt lgkmcnt(3)
    v_fma_f32 v224, v15, v224, v136
    v_fma_f32 v225, v15, v225, v137
    v_fma_f32 v226, v15, v226, v138
    v_fma_f32 v227, v15, v227, v139
    s_waitcnt lgkmcnt(2)
    v_fma_f32 v228, v15, v228, v140
    v_fma_f32 v229, v15, v229, v141
    v_fma_f32 v230, v15, v230, v142
    v_fma_f32 v231, v15, v231, v143
    s_waitcnt lgkmcnt(1)
    v_fma_f32 v232, v15, v232, v144
    v_fma_f32 v233, v15, v233, v145
    v_fma_f32 v234, v15, v234, v146
    v_fma_f32 v235, v15, v235, v147
    s_waitcnt lgkmcnt(0)
    v_fma_f32 v236, v15, v236, v148
    v_fma_f32 v237, v15, v237, v149
    v_fma_f32 v238, v15, v238, v150
    v_fma_f32 v239, v15, v239, v151
    v_mul_f32 v240, v224, v16
    v_mul_f32 v241, v225, v16
    v_mul_f32 v242, v226, v16
    v_mul_f32 v243, v227, v16
    v_mul_f32 v244, v228, v16
    v_mul_f32 v245, v229, v16
    v_mul_f32 v246, v230, v16
    v_mul_f32 v247, v231, v16
    v_exp_f32 v240, v240
    v_exp_f32 v241, v241
    v_exp_f32 v242, v242
    v_exp_f32 v243, v243
    v_exp_f32 v244, v244
    v_exp_f32 v245, v245
    v_exp_f32 v246, v246
    v_exp_f32 v247, v247
    v_mul_f32 v224, v224, v232
    v_mul_f32 v225, v225, v233
    v_mul_f32 v226, v226, v234
    v_mul_f32 v227, v227, v235
    v_mul_f32 v228, v228, v236
    v_mul_f32 v229, v229, v237
    v_mul_f32 v230, v230, v238
    v_mul_f32 v231, v231, v239
    v_fma_f32 v240, v240, v17, v17
    v_fma_f32 v241, v241, v17, v17
    v_fma_f32 v242, v242, v17, v17
    v_fma_f32 v243, v243, v17, v17
    v_fma_f32 v244, v244, v17, v17
    v_fma_f32 v245, v245, v17, v17
    v_fma_f32 v246, v246, v17, v17
    v_fma_f32 v247, v247, v17, v17
    v_rcp_f32 v240, v240
    v_rcp_f32 v241, v241
    v_rcp_f32 v242, v242
    v_rcp_f32 v243, v243
    v_rcp_f32 v244, v244
    v_rcp_f32 v245, v245
    v_rcp_f32 v246, v246
    v_rcp_f32 v247, v247
    v_mul_f32 v224, v224, v240
    v_mul_f32 v225, v225, v241
    v_mul_f32 v226, v226, v242
    v_mul_f32 v227, v227, v243
    v_mul_f32 v228, v228, v244
    v_mul_f32 v229, v229, v245
    v_mul_f32 v230, v230, v246
    v_mul_f32 v231, v231, v247
    v_cvt_pk_bf16_f32 v248, v224, v225
    v_cvt_pk_bf16_f32 v249, v226, v227
    v_cvt_pk_bf16_f32 v250, v228, v229
    v_cvt_pk_bf16_f32 v251, v230, v231
    s_add_u32 s50, s95, 49152
    buffer_store_dwordx4 v[248:251], v6, s[32:35], s50 offen sc1
    s_waitcnt vmcnt(19)
    v_mfma_f32_32x32x16_bf16 v[136:151], a[0:3], v[24:27], 0
    s_add_u32 s49, s82, 16384
    buffer_load_dwordx4 v[88:91], v6, s[32:35], s49 offen offset:0 sc1
    v_mfma_f32_32x32x16_bf16 v[152:167], a[4:7], v[24:27], 0
    s_waitcnt vmcnt(19)
    v_mfma_f32_32x32x16_bf16 v[168:183], a[0:3], v[28:31], 0
    buffer_load_dwordx4 v[92:95], v6, s[32:35], s49 offen offset:1024 sc1
    v_mfma_f32_32x32x16_bf16 v[184:199], a[4:7], v[28:31], 0
    s_waitcnt vmcnt(19)
    v_mfma_f32_32x32x16_bf16 v[136:151], a[8:11], v[32:35], v[136:151]
    buffer_load_dwordx4 v[96:99], v6, s[32:35], s49 offen offset:2048 sc1
    v_mfma_f32_32x32x16_bf16 v[152:167], a[12:15], v[32:35], v[152:167]
    s_waitcnt vmcnt(19)
    v_mfma_f32_32x32x16_bf16 v[168:183], a[8:11], v[36:39], v[168:183]
    buffer_load_dwordx4 v[100:103], v6, s[32:35], s49 offen offset:3072 sc1
    v_mfma_f32_32x32x16_bf16 v[184:199], a[12:15], v[36:39], v[184:199]
    s_waitcnt vmcnt(19)
    v_mfma_f32_32x32x16_bf16 v[136:151], a[16:19], v[40:43], v[136:151]
    s_add_u32 s49, s82, 20480
    buffer_load_dwordx4 v[104:107], v6, s[32:35], s49 offen offset:0 sc1
    v_mfma_f32_32x32x16_bf16 v[152:167], a[20:23], v[40:43], v[152:167]
    s_waitcnt vmcnt(19)
    v_mfma_f32_32x32x16_bf16 v[168:183], a[16:19], v[44:47], v[168:183]
    buffer_load_dwordx4 v[108:111], v6, s[32:35], s49 offen offset:1024 sc1
    v_mfma_f32_32x32x16_bf16 v[184:199], a[20:23], v[44:47], v[184:199]
    s_waitcnt vmcnt(19)
    v_mfma_f32_32x32x16_bf16 v[136:151], a[24:27], v[48:51], v[136:151]
    buffer_load_dwordx4 v[112:115], v6, s[32:35], s49 offen offset:2048 sc1
    v_mfma_f32_32x32x16_bf16 v[152:167], a[28:31], v[48:51], v[152:167]
    s_waitcnt vmcnt(19)
    v_mfma_f32_32x32x16_bf16 v[168:183], a[24:27], v[52:55], v[168:183]
    buffer_load_dwordx4 v[116:119], v6, s[32:35], s49 offen offset:3072 sc1
    v_mfma_f32_32x32x16_bf16 v[184:199], a[28:31], v[52:55], v[184:199]
    s_barrier
    s_waitcnt vmcnt(19)
    v_mfma_f32_32x32x16_bf16 v[136:151], a[32:35], v[56:59], v[136:151]
    s_add_u32 s49, s82, 24576
    buffer_load_dwordx4 v[24:27], v6, s[32:35], s49 offen offset:0 sc1
    v_mfma_f32_32x32x16_bf16 v[152:167], a[36:39], v[56:59], v[152:167]
    s_waitcnt vmcnt(19)
    v_mfma_f32_32x32x16_bf16 v[168:183], a[32:35], v[60:63], v[168:183]
    buffer_load_dwordx4 v[28:31], v6, s[32:35], s49 offen offset:1024 sc1
    v_mfma_f32_32x32x16_bf16 v[184:199], a[36:39], v[60:63], v[184:199]
    s_waitcnt vmcnt(19)
    v_mfma_f32_32x32x16_bf16 v[136:151], a[40:43], v[64:67], v[136:151]
    buffer_load_dwordx4 v[32:35], v6, s[32:35], s49 offen offset:2048 sc1
    v_mfma_f32_32x32x16_bf16 v[152:167], a[44:47], v[64:67], v[152:167]
    s_waitcnt vmcnt(19)
    v_mfma_f32_32x32x16_bf16 v[168:183], a[40:43], v[68:71], v[168:183]
    buffer_load_dwordx4 v[36:39], v6, s[32:35], s49 offen offset:3072 sc1
    v_mfma_f32_32x32x16_bf16 v[184:199], a[44:47], v[68:71], v[184:199]
    s_waitcnt vmcnt(11)
    v_max3_u32 v19, v88, v89, v90
    s_waitcnt vmcnt(10)
    v_max3_u32 v19, v19, v91, v92
    v_mfma_f32_32x32x16_bf16 v[136:151], a[48:51], v[72:75], v[136:151]
    s_add_u32 s49, s82, 28672
    buffer_load_dwordx4 v[40:43], v6, s[32:35], s49 offen offset:0 sc1
    v_max3_u32 v19, v19, v93, v94
    s_waitcnt vmcnt(10)
    v_max3_u32 v19, v19, v95, v96
    v_mfma_f32_32x32x16_bf16 v[152:167], a[52:55], v[72:75], v[152:167]
    v_max3_u32 v19, v19, v97, v98
    s_waitcnt vmcnt(9)
    v_max3_u32 v19, v19, v99, v100
    v_mfma_f32_32x32x16_bf16 v[168:183], a[48:51], v[76:79], v[168:183]
    buffer_load_dwordx4 v[44:47], v6, s[32:35], s49 offen offset:1024 sc1
    v_max3_u32 v19, v19, v101, v102
    s_waitcnt vmcnt(9)
    v_max3_u32 v19, v19, v103, v104
    v_mfma_f32_32x32x16_bf16 v[184:199], a[52:55], v[76:79], v[184:199]
    v_max3_u32 v19, v19, v105, v106
    s_waitcnt vmcnt(8)
    v_max3_u32 v19, v19, v107, v108
    v_mfma_f32_32x32x16_bf16 v[136:151], a[56:59], v[80:83], v[136:151]
    buffer_load_dwordx4 v[48:51], v6, s[32:35], s49 offen offset:2048 sc1
    v_max3_u32 v19, v19, v109, v110
    s_waitcnt vmcnt(8)
    v_max3_u32 v19, v19, v111, v112
    v_mfma_f32_32x32x16_bf16 v[152:167], a[60:63], v[80:83], v[152:167]
    v_max3_u32 v19, v19, v113, v114
    s_waitcnt vmcnt(7)
    v_max3_u32 v19, v19, v115, v116
    v_mfma_f32_32x32x16_bf16 v[168:183], a[56:59], v[84:87], v[168:183]
    buffer_load_dwordx4 v[52:55], v6, s[32:35], s49 offen offset:3072 sc1
    v_max3_u32 v19, v19, v117, v118
    v_max_u32 v19, v19, v119
    v_mfma_f32_32x32x16_bf16 v[184:199], a[60:63], v[84:87], v[184:199]
    v_cmp_eq_u32 s[62:63], -1, v19
    s_nop 0
    s_cmp_eq_u64 s[62:63], 0
    s_cbranch_scc1 valok_41
    s_mov_b32 s61, 0
valre_42:
    s_add_u32 s49, s82, 16384
    buffer_load_dwordx4 v[88:91], v6, s[32:35], s49 offen offset:0 sc1
    buffer_load_dwordx4 v[92:95], v6, s[32:35], s49 offen offset:1024 sc1
    buffer_load_dwordx4 v[96:99], v6, s[32:35], s49 offen offset:2048 sc1
    buffer_load_dwordx4 v[100:103], v6, s[32:35], s49 offen offset:3072 sc1
    s_add_u32 s49, s82, 20480
    buffer_load_dwordx4 v[104:107], v6, s[32:35], s49 offen offset:0 sc1
    buffer_load_dwordx4 v[108:111], v6, s[32:35], s49 offen offset:1024 sc1
    buffer_load_dwordx4 v[112:115], v6, s[32:35], s49 offen offset:2048 sc1
    buffer_load_dwordx4 v[116:119], v6, s[32:35], s49 offen offset:3072 sc1
    s_waitcnt vmcnt(0)
    s_nop 0
    v_max3_u32 v19, v88, v89, v90
    v_max3_u32 v19, v19, v91, v92
    v_max3_u32 v19, v19, v93, v94
    v_max3_u32 v19, v19, v95, v96
    v_max3_u32 v19, v19, v97, v98
    v_max3_u32 v19, v19, v99, v100
    v_max3_u32 v19, v19, v101, v102
    v_max3_u32 v19, v19, v103, v104
    v_max3_u32 v19, v19, v105, v106
    v_max3_u32 v19, v19, v107, v108
    v_max3_u32 v19, v19, v109, v110
    v_max3_u32 v19, v19, v111, v112
    v_max3_u32 v19, v19, v113, v114
    v_max3_u32 v19, v19, v115, v116
    v_max3_u32 v19, v19, v117, v118
    v_max_u32 v19, v19, v119
    v_cmp_eq_u32 s[62:63], -1, v19
    s_nop 0
    s_cmp_eq_u64 s[62:63], 0
    s_cbranch_scc1 valok_41
    s_add_u32 s61, s61, 1
    s_cmp_gt_u32 s61, 32768
    s_cbranch_scc0 valre_42
valok_41:
    v_mfma_f32_32x32x16_bf16 v[136:151], a[64:67], v[88:91], v[136:151]
    s_add_u32 s49, s82, 32768
    buffer_load_dwordx4 v[56:59], v6, s[32:35], s49 offen offset:0 sc1
    v_mfma_f32_32x32x16_bf16 v[152:167], a[68:71], v[88:91], v[152:167]
    v_mfma_f32_32x32x16_bf16 v[168:183], a[64:67], v[92:95], v[168:183]
    buffer_load_dwordx4 v[60:63], v6, s[32:35], s49 offen offset:1024 sc1
    v_mfma_f32_32x32x16_bf16 v[184:199], a[68:71], v[92:95], v[184:199]
    v_mfma_f32_32x32x16_bf16 v[136:151], a[72:75], v[96:99], v[136:151]
    buffer_load_dwordx4 v[64:67], v6, s[32:35], s49 offen offset:2048 sc1
    v_mfma_f32_32x32x16_bf16 v[152:167], a[76:79], v[96:99], v[152:167]
    v_mfma_f32_32x32x16_bf16 v[168:183], a[72:75], v[100:103], v[168:183]
    buffer_load_dwordx4 v[68:71], v6, s[32:35], s49 offen offset:3072 sc1
    v_mfma_f32_32x32x16_bf16 v[184:199], a[76:79], v[100:103], v[184:199]
    s_waitcnt vmcnt(11)
    v_max3_u32 v19, v24, v25, v26
    s_waitcnt vmcnt(10)
    v_max3_u32 v19, v19, v27, v28
    v_mfma_f32_32x32x16_bf16 v[136:151], a[80:83], v[104:107], v[136:151]
    s_add_u32 s49, s82, 36864
    buffer_load_dwordx4 v[72:75], v6, s[32:35], s49 offen offset:0 sc1
    v_max3_u32 v19, v19, v29, v30
    s_waitcnt vmcnt(10)
    v_max3_u32 v19, v19, v31, v32
    v_mfma_f32_32x32x16_bf16 v[152:167], a[84:87], v[104:107], v[152:167]
    v_max3_u32 v19, v19, v33, v34
    s_waitcnt vmcnt(9)
    v_max3_u32 v19, v19, v35, v36
    v_mfma_f32_32x32x16_bf16 v[168:183], a[80:83], v[108:111], v[168:183]
    buffer_load_dwordx4 v[76:79], v6, s[32:35], s49 offen offset:1024 sc1
    v_max3_u32 v19, v19, v37, v38
    s_waitcnt vmcnt(9)
    v_max3_u32 v19, v19, v39, v40
    v_mfma_f32_32x32x16_bf16 v[184:199], a[84:87], v[108:111], v[184:199]
    v_max3_u32 v19, v19, v41, v42
    s_waitcnt vmcnt(8)
    v_max3_u32 v19, v19, v43, v44
    v_mfma_f32_32x32x16_bf16 v[136:151], a[88:91], v[112:115], v[136:151]
    buffer_load_dwordx4 v[80:83], v6, s[32:35], s49 offen offset:2048 sc1
    v_max3_u32 v19, v19, v45, v46
    s_waitcnt vmcnt(8)
    v_max3_u32 v19, v19, v47, v48
    v_mfma_f32_32x32x16_bf16 v[152:167], a[92:95], v[112:115], v[152:167]
    v_max3_u32 v19, v19, v49, v50
    s_waitcnt vmcnt(7)
    v_max3_u32 v19, v19, v51, v52
    v_mfma_f32_32x32x16_bf16 v[168:183], a[88:91], v[116:119], v[168:183]
    buffer_load_dwordx4 v[84:87], v6, s[32:35], s49 offen offset:3072 sc1
    v_max3_u32 v19, v19, v53, v54
    v_max_u32 v19, v19, v55
    v_mfma_f32_32x32x16_bf16 v[184:199], a[92:95], v[116:119], v[184:199]
    v_cmp_eq_u32 s[62:63], -1, v19
    s_nop 0
    s_cmp_eq_u64 s[62:63], 0
    s_cbranch_scc1 valok_43
    s_mov_b32 s61, 0
valre_44:
    s_nop 0
    s_add_u32 s49, s82, 24576
    buffer_load_dwordx4 v[24:27], v6, s[32:35], s49 offen offset:0 sc1
    buffer_load_dwordx4 v[28:31], v6, s[32:35], s49 offen offset:1024 sc1
    buffer_load_dwordx4 v[32:35], v6, s[32:35], s49 offen offset:2048 sc1
    buffer_load_dwordx4 v[36:39], v6, s[32:35], s49 offen offset:3072 sc1
    s_add_u32 s49, s82, 28672
    buffer_load_dwordx4 v[40:43], v6, s[32:35], s49 offen offset:0 sc1
    buffer_load_dwordx4 v[44:47], v6, s[32:35], s49 offen offset:1024 sc1
    buffer_load_dwordx4 v[48:51], v6, s[32:35], s49 offen offset:2048 sc1
    buffer_load_dwordx4 v[52:55], v6, s[32:35], s49 offen offset:3072 sc1
    s_waitcnt vmcnt(0)
    s_nop 0
    v_max3_u32 v19, v24, v25, v26
    v_max3_u32 v19, v19, v27, v28
    v_max3_u32 v19, v19, v29, v30
    v_max3_u32 v19, v19, v31, v32
    v_max3_u32 v19, v19, v33, v34
    v_max3_u32 v19, v19, v35, v36
    v_max3_u32 v19, v19, v37, v38
    v_max3_u32 v19, v19, v39, v40
    v_max3_u32 v19, v19, v41, v42
    v_max3_u32 v19, v19, v43, v44
    v_max3_u32 v19, v19, v45, v46
    v_max3_u32 v19, v19, v47, v48
    v_max3_u32 v19, v19, v49, v50
    v_max3_u32 v19, v19, v51, v52
    v_max3_u32 v19, v19, v53, v54
    v_max_u32 v19, v19, v55
    v_cmp_eq_u32 s[62:63], -1, v19
    s_nop 0
    s_cmp_eq_u64 s[62:63], 0
    s_cbranch_scc1 valok_43
    s_add_u32 s61, s61, 1
    s_cmp_gt_u32 s61, 32768
    s_cbranch_scc0 valre_44
valok_43:
    v_mfma_f32_32x32x16_bf16 v[136:151], a[96:99], v[24:27], v[136:151]
    s_add_u32 s49, s82, 40960
    buffer_load_dwordx4 v[88:91], v6, s[32:35], s49 offen offset:0 sc1
    v_mfma_f32_32x32x16_bf16 v[152:167], a[100:103], v[24:27], v[152:167]
    v_mfma_f32_32x32x16_bf16 v[168:183], a[96:99], v[28:31], v[168:183]
    buffer_load_dwordx4 v[92:95], v6, s[32:35], s49 offen offset:1024 sc1
    v_mfma_f32_32x32x16_bf16 v[184:199], a[100:103], v[28:31], v[184:199]
    v_mfma_f32_32x32x16_bf16 v[136:151], a[104:107], v[32:35], v[136:151]
    buffer_load_dwordx4 v[96:99], v6, s[32:35], s49 offen offset:2048 sc1
    v_mfma_f32_32x32x16_bf16 v[152:167], a[108:111], v[32:35], v[152:167]
    v_mfma_f32_32x32x16_bf16 v[168:183], a[104:107], v[36:39], v[168:183]
    buffer_load_dwordx4 v[100:103], v6, s[32:35], s49 offen offset:3072 sc1
    v_mfma_f32_32x32x16_bf16 v[184:199], a[108:111], v[36:39], v[184:199]
    s_waitcnt vmcnt(11)
    v_max3_u32 v19, v56, v57, v58
    s_waitcnt vmcnt(10)
    v_max3_u32 v19, v19, v59, v60
    v_mfma_f32_32x32x16_bf16 v[136:151], a[112:115], v[40:43], v[136:151]
    s_add_u32 s49, s82, 45056
    buffer_load_dwordx4 v[104:107], v6, s[32:35], s49 offen offset:0 sc1
    v_max3_u32 v19, v19, v61, v62
    s_waitcnt vmcnt(10)
    v_max3_u32 v19, v19, v63, v64
    v_mfma_f32_32x32x16_bf16 v[152:167], a[116:119], v[40:43], v[152:167]
    v_max3_u32 v19, v19, v65, v66
    s_waitcnt vmcnt(9)
    v_max3_u32 v19, v19, v67, v68
    v_mfma_f32_32x32x16_bf16 v[168:183], a[112:115], v[44:47], v[168:183]
    buffer_load_dwordx4 v[108:111], v6, s[32:35], s49 offen offset:1024 sc1
    v_max3_u32 v19, v19, v69, v70
    s_waitcnt vmcnt(9)
    v_max3_u32 v19, v19, v71, v72
    v_mfma_f32_32x32x16_bf16 v[184:199], a[116:119], v[44:47], v[184:199]
    v_max3_u32 v19, v19, v73, v74
    s_waitcnt vmcnt(8)
    v_max3_u32 v19, v19, v75, v76
    v_mfma_f32_32x32x16_bf16 v[136:151], a[120:123], v[48:51], v[136:151]
    buffer_load_dwordx4 v[112:115], v6, s[32:35], s49 offen offset:2048 sc1
    v_max3_u32 v19, v19, v77, v78
    s_waitcnt vmcnt(8)
    v_max3_u32 v19, v19, v79, v80
    v_mfma_f32_32x32x16_bf16 v[152:167], a[124:127], v[48:51], v[152:167]
    v_max3_u32 v19, v19, v81, v82
    s_waitcnt vmcnt(7)
    v_max3_u32 v19, v19, v83, v84
    v_mfma_f32_32x32x16_bf16 v[168:183], a[120:123], v[52:55], v[168:183]
    buffer_load_dwordx4 v[116:119], v6, s[32:35], s49 offen offset:3072 sc1
    v_max3_u32 v19, v19, v85, v86
    v_max_u32 v19, v19, v87
    v_mfma_f32_32x32x16_bf16 v[184:199], a[124:127], v[52:55], v[184:199]
    v_cmp_eq_u32 s[62:63], -1, v19
    s_nop 0
    s_cmp_eq_u64 s[62:63], 0
    s_cbranch_scc1 valok_45
    s_mov_b32 s61, 0
valre_46:
    s_nop 0
    s_add_u32 s49, s82, 32768
    buffer_load_dwordx4 v[56:59], v6, s[32:35], s49 offen offset:0 sc1
    buffer_load_dwordx4 v[60:63], v6, s[32:35], s49 offen offset:1024 sc1
    buffer_load_dwordx4 v[64:67], v6, s[32:35], s49 offen offset:2048 sc1
    buffer_load_dwordx4 v[68:71], v6, s[32:35], s49 offen offset:3072 sc1
    s_add_u32 s49, s82, 36864
    buffer_load_dwordx4 v[72:75], v6, s[32:35], s49 offen offset:0 sc1
    buffer_load_dwordx4 v[76:79], v6, s[32:35], s49 offen offset:1024 sc1
    buffer_load_dwordx4 v[80:83], v6, s[32:35], s49 offen offset:2048 sc1
    buffer_load_dwordx4 v[84:87], v6, s[32:35], s49 offen offset:3072 sc1
    s_waitcnt vmcnt(0)
    s_nop 0
    v_max3_u32 v19, v56, v57, v58
    v_max3_u32 v19, v19, v59, v60
    v_max3_u32 v19, v19, v61, v62
    v_max3_u32 v19, v19, v63, v64
    v_max3_u32 v19, v19, v65, v66
    v_max3_u32 v19, v19, v67, v68
    v_max3_u32 v19, v19, v69, v70
    v_max3_u32 v19, v19, v71, v72
    v_max3_u32 v19, v19, v73, v74
    v_max3_u32 v19, v19, v75, v76
    v_max3_u32 v19, v19, v77, v78
    v_max3_u32 v19, v19, v79, v80
    v_max3_u32 v19, v19, v81, v82
    v_max3_u32 v19, v19, v83, v84
    v_max3_u32 v19, v19, v85, v86
    v_max_u32 v19, v19, v87
    v_cmp_eq_u32 s[62:63], -1, v19
    s_nop 0
    s_cmp_eq_u64 s[62:63], 0
    s_cbranch_scc1 valok_45
    s_add_u32 s61, s61, 1
    s_cmp_gt_u32 s61, 32768
    s_cbranch_scc0 valre_46
valok_45:
    v_mfma_f32_32x32x16_bf16 v[136:151], a[128:131], v[56:59], v[136:151]
    s_add_u32 s49, s82, 49152
    buffer_load_dwordx4 v[24:27], v6, s[32:35], s49 offen offset:0 sc1
    v_mfma_f32_32x32x16_bf16 v[152:167], a[132:135], v[56:59], v[152:167]
    v_mfma_f32_32x32x16_bf16 v[168:183], a[128:131], v[60:63], v[168:183]
    buffer_load_dwordx4 v[28:31], v6, s[32:35], s49 offen offset:1024 sc1
    v_mfma_f32_32x32x16_bf16 v[184:199], a[132:135], v[60:63], v[184:199]
    v_mfma_f32_32x32x16_bf16 v[136:151], a[136:139], v[64:67], v[136:151]
    buffer_load_dwordx4 v[32:35], v6, s[32:35], s49 offen offset:2048 sc1
    v_mfma_f32_32x32x16_bf16 v[152:167], a[140:143], v[64:67], v[152:167]
    v_mfma_f32_32x32x16_bf16 v[168:183], a[136:139], v[68:71], v[168:183]
    buffer_load_dwordx4 v[36:39], v6, s[32:35], s49 offen offset:3072 sc1
    v_mfma_f32_32x32x16_bf16 v[184:199], a[140:143], v[68:71], v[184:199]
    s_waitcnt vmcnt(11)
    v_max3_u32 v19, v88, v89, v90
    s_waitcnt vmcnt(10)
    v_max3_u32 v19, v19, v91, v92
    v_mfma_f32_32x32x16_bf16 v[136:151], a[144:147], v[72:75], v[136:151]
    s_add_u32 s49, s82, 53248
    buffer_load_dwordx4 v[40:43], v6, s[32:35], s49 offen offset:0 sc1
    v_max3_u32 v19, v19, v93, v94
    s_waitcnt vmcnt(10)
    v_max3_u32 v19, v19, v95, v96
    v_mfma_f32_32x32x16_bf16 v[152:167], a[148:151], v[72:75], v[152:167]
    v_max3_u32 v19, v19, v97, v98
    s_waitcnt vmcnt(9)
    v_max3_u32 v19, v19, v99, v100
    v_mfma_f32_32x32x16_bf16 v[168:183], a[144:147], v[76:79], v[168:183]
    buffer_load_dwordx4 v[44:47], v6, s[32:35], s49 offen offset:1024 sc1
    v_max3_u32 v19, v19, v101, v102
    s_waitcnt vmcnt(9)
    v_max3_u32 v19, v19, v103, v104
    v_mfma_f32_32x32x16_bf16 v[184:199], a[148:151], v[76:79], v[184:199]
    v_max3_u32 v19, v19, v105, v106
    s_waitcnt vmcnt(8)
    v_max3_u32 v19, v19, v107, v108
    v_mfma_f32_32x32x16_bf16 v[136:151], a[152:155], v[80:83], v[136:151]
    buffer_load_dwordx4 v[48:51], v6, s[32:35], s49 offen offset:2048 sc1
    v_max3_u32 v19, v19, v109, v110
    s_waitcnt vmcnt(8)
    v_max3_u32 v19, v19, v111, v112
    v_mfma_f32_32x32x16_bf16 v[152:167], a[156:159], v[80:83], v[152:167]
    v_max3_u32 v19, v19, v113, v114
    s_waitcnt vmcnt(7)
    v_max3_u32 v19, v19, v115, v116
    v_mfma_f32_32x32x16_bf16 v[168:183], a[152:155], v[84:87], v[168:183]
    buffer_load_dwordx4 v[52:55], v6, s[32:35], s49 offen offset:3072 sc1
    v_max3_u32 v19, v19, v117, v118
    v_max_u32 v19, v19, v119
    v_mfma_f32_32x32x16_bf16 v[184:199], a[156:159], v[84:87], v[184:199]
    v_cmp_eq_u32 s[62:63], -1, v19
    s_nop 0
    s_cmp_eq_u64 s[62:63], 0
    s_cbranch_scc1 valok_47
    s_mov_b32 s61, 0
valre_48:
    s_nop 0
    s_add_u32 s49, s82, 40960
    buffer_load_dwordx4 v[88:91], v6, s[32:35], s49 offen offset:0 sc1
    buffer_load_dwordx4 v[92:95], v6, s[32:35], s49 offen offset:1024 sc1
    buffer_load_dwordx4 v[96:99], v6, s[32:35], s49 offen offset:2048 sc1
    buffer_load_dwordx4 v[100:103], v6, s[32:35], s49 offen offset:3072 sc1
    s_add_u32 s49, s82, 45056
    buffer_load_dwordx4 v[104:107], v6, s[32:35], s49 offen offset:0 sc1
    buffer_load_dwordx4 v[108:111], v6, s[32:35], s49 offen offset:1024 sc1
    buffer_load_dwordx4 v[112:115], v6, s[32:35], s49 offen offset:2048 sc1
    buffer_load_dwordx4 v[116:119], v6, s[32:35], s49 offen offset:3072 sc1
    s_waitcnt vmcnt(0)
    s_nop 0
    v_max3_u32 v19, v88, v89, v90
    v_max3_u32 v19, v19, v91, v92
    v_max3_u32 v19, v19, v93, v94
    v_max3_u32 v19, v19, v95, v96
    v_max3_u32 v19, v19, v97, v98
    v_max3_u32 v19, v19, v99, v100
    v_max3_u32 v19, v19, v101, v102
    v_max3_u32 v19, v19, v103, v104
    v_max3_u32 v19, v19, v105, v106
    v_max3_u32 v19, v19, v107, v108
    v_max3_u32 v19, v19, v109, v110
    v_max3_u32 v19, v19, v111, v112
    v_max3_u32 v19, v19, v113, v114
    v_max3_u32 v19, v19, v115, v116
    v_max3_u32 v19, v19, v117, v118
    v_max_u32 v19, v19, v119
    v_cmp_eq_u32 s[62:63], -1, v19
    s_nop 0
    s_cmp_eq_u64 s[62:63], 0
    s_cbranch_scc1 valok_47
    s_add_u32 s61, s61, 1
    s_cmp_gt_u32 s61, 32768
    s_cbranch_scc0 valre_48
valok_47:
    v_mfma_f32_32x32x16_bf16 v[136:151], a[160:163], v[88:91], v[136:151]
    v_mfma_f32_32x32x16_bf16 v[152:167], a[164:167], v[88:91], v[152:167]
    v_mfma_f32_32x32x16_bf16 v[168:183], a[160:163], v[92:95], v[168:183]
    v_mfma_f32_32x32x16_bf16 v[184:199], a[164:167], v[92:95], v[184:199]
    v_mfma_f32_32x32x16_bf16 v[136:151], a[168:171], v[96:99], v[136:151]
    v_mfma_f32_32x32x16_bf16 v[152:167], a[172:175], v[96:99], v[152:167]
    v_mfma_f32_32x32x16_bf16 v[168:183], a[168:171], v[100:103], v[168:183]
    v_mfma_f32_32x32x16_bf16 v[184:199], a[172:175], v[100:103], v[184:199]
    s_waitcnt vmcnt(7)
    v_max3_u32 v19, v24, v25, v26
    s_waitcnt vmcnt(6)
    v_max3_u32 v19, v19, v27, v28
    v_mfma_f32_32x32x16_bf16 v[136:151], a[176:179], v[104:107], v[136:151]
    v_max3_u32 v19, v19, v29, v30
    s_waitcnt vmcnt(5)
    v_max3_u32 v19, v19, v31, v32
    v_mfma_f32_32x32x16_bf16 v[152:167], a[180:183], v[104:107], v[152:167]
    v_max3_u32 v19, v19, v33, v34
    s_waitcnt vmcnt(4)
    v_max3_u32 v19, v19, v35, v36
    v_mfma_f32_32x32x16_bf16 v[168:183], a[176:179], v[108:111], v[168:183]
    v_max3_u32 v19, v19, v37, v38
    s_waitcnt vmcnt(3)
    v_max3_u32 v19, v19, v39, v40
    v_mfma_f32_32x32x16_bf16 v[184:199], a[180:183], v[108:111], v[184:199]
    v_max3_u32 v19, v19, v41, v42
    s_waitcnt vmcnt(2)
    v_max3_u32 v19, v19, v43, v44
    v_mfma_f32_32x32x16_bf16 v[136:151], a[184:187], v[112:115], v[136:151]
    v_max3_u32 v19, v19, v45, v46
    s_waitcnt vmcnt(1)
    v_max3_u32 v19, v19, v47, v48
    v_mfma_f32_32x32x16_bf16 v[152:167], a[188:191], v[112:115], v[152:167]
    v_max3_u32 v19, v19, v49, v50
    s_waitcnt vmcnt(0)
    v_max3_u32 v19, v19, v51, v52
    v_mfma_f32_32x32x16_bf16 v[168:183], a[184:187], v[116:119], v[168:183]
    v_max3_u32 v19, v19, v53, v54
    v_max_u32 v19, v19, v55
    v_mfma_f32_32x32x16_bf16 v[184:199], a[188:191], v[116:119], v[184:199]
    v_cmp_eq_u32 s[62:63], -1, v19
    s_nop 0
    s_cmp_eq_u64 s[62:63], 0
    s_cbranch_scc1 valok_49
    s_mov_b32 s61, 0
valre_50:
    s_nop 0
    s_add_u32 s49, s82, 49152
    buffer_load_dwordx4 v[24:27], v6, s[32:35], s49 offen offset:0 sc1
    buffer_load_dwordx4 v[28:31], v6, s[32:35], s49 offen offset:1024 sc1
    buffer_load_dwordx4 v[32:35], v6, s[32:35], s49 offen offset:2048 sc1
    buffer_load_dwordx4 v[36:39], v6, s[32:35], s49 offen offset:3072 sc1
    s_add_u32 s49, s82, 53248
    buffer_load_dwordx4 v[40:43], v6, s[32:35], s49 offen offset:0 sc1
    buffer_load_dwordx4 v[44:47], v6, s[32:35], s49 offen offset:1024 sc1
    buffer_load_dwordx4 v[48:51], v6, s[32:35], s49 offen offset:2048 sc1
    buffer_load_dwordx4 v[52:55], v6, s[32:35], s49 offen offset:3072 sc1
    s_waitcnt vmcnt(0)
    s_nop 0
    v_max3_u32 v19, v24, v25, v26
    v_max3_u32 v19, v19, v27, v28
    v_max3_u32 v19, v19, v29, v30
    v_max3_u32 v19, v19, v31, v32
    v_max3_u32 v19, v19, v33, v34
    v_max3_u32 v19, v19, v35, v36
    v_max3_u32 v19, v19, v37, v38
    v_max3_u32 v19, v19, v39, v40
    v_max3_u32 v19, v19, v41, v42
    v_max3_u32 v19, v19, v43, v44
    v_max3_u32 v19, v19, v45, v46
    v_max3_u32 v19, v19, v47, v48
    v_max3_u32 v19, v19, v49, v50
    v_max3_u32 v19, v19, v51, v52
    v_max3_u32 v19, v19, v53, v54
    v_max_u32 v19, v19, v55
    v_cmp_eq_u32 s[62:63], -1, v19
    s_nop 0
    s_cmp_eq_u64 s[62:63], 0
    s_cbranch_scc1 valok_49
    s_add_u32 s61, s61, 1
    s_cmp_gt_u32 s61, 32768
    s_cbranch_scc0 valre_50
valok_49:
    s_mul_i32 s49, s48, 16896
    v_add_u32_e64 v132, s49, v6
    v_mfma_f32_32x32x16_bf16 v[136:151], a[192:195], v[24:27], v[136:151]
    v_mfma_f32_32x32x16_bf16 v[136:151], a[200:203], v[32:35], v[136:151]
    v_mfma_f32_32x32x16_bf16 v[136:151], a[208:211], v[40:43], v[136:151]
    v_mfma_f32_32x32x16_bf16 v[136:151], a[216:219], v[48:51], v[136:151]
    v_mfma_f32_32x32x16_bf16 v[152:167], a[196:199], v[24:27], v[152:167]
    v_mfma_f32_32x32x16_bf16 v[152:167], a[204:207], v[32:35], v[152:167]
    v_mfma_f32_32x32x16_bf16 v[152:167], a[212:215], v[40:43], v[152:167]
    s_nop 8
    s_nop 0
    ds_write_b128 v132, v[136:139] offset:0
    ds_write_b128 v132, v[140:143] offset:1056
    v_mfma_f32_32x32x16_bf16 v[152:167], a[220:223], v[48:51], v[152:167]
    ds_write_b128 v132, v[144:147] offset:2112
    ds_write_b128 v132, v[148:151] offset:3168
    v_mfma_f32_32x32x16_bf16 v[168:183], a[192:195], v[28:31], v[168:183]
    v_mfma_f32_32x32x16_bf16 v[168:183], a[200:203], v[36:39], v[168:183]
    v_mfma_f32_32x32x16_bf16 v[168:183], a[208:211], v[44:47], v[168:183]
    s_nop 6
    s_nop 0
    ds_write_b128 v132, v[152:155] offset:4224
    ds_write_b128 v132, v[156:159] offset:5280
    v_mfma_f32_32x32x16_bf16 v[168:183], a[216:219], v[52:55], v[168:183]
    ds_write_b128 v132, v[160:163] offset:6336
    ds_write_b128 v132, v[164:167] offset:7392
    v_mfma_f32_32x32x16_bf16 v[184:199], a[196:199], v[28:31], v[184:199]
    v_mfma_f32_32x32x16_bf16 v[184:199], a[204:207], v[36:39], v[184:199]
    v_mfma_f32_32x32x16_bf16 v[184:199], a[212:215], v[44:47], v[184:199]
    s_nop 6
    ds_write_b128 v132, v[168:171] offset:8448
    ds_write_b128 v132, v[172:175] offset:9504
    v_mfma_f32_32x32x16_bf16 v[184:199], a[220:223], v[52:55], v[184:199]
    ds_write_b128 v132, v[176:179] offset:10560
    ds_write_b128 v132, v[180:183] offset:11616
    s_nop 9
    ds_write_b128 v132, v[184:187] offset:12672
    ds_write_b128 v132, v[188:191] offset:13728
    ds_write_b128 v132, v[192:195] offset:14784
    ds_write_b128 v132, v[196:199] offset:15840
    s_waitcnt lgkmcnt(0)
    s_barrier
    ds_read_b128 v[24:27], v131 offset:0
    ds_read_b128 v[28:31], v131 offset:512
    ds_read_b128 v[32:35], v131 offset:16896
    ds_read_b128 v[36:39], v131 offset:17408
    ds_read_b128 v[40:43], v131 offset:33792
    ds_read_b128 v[44:47], v131 offset:34304
    ds_read_b128 v[48:51], v131 offset:50688
    ds_read_b128 v[52:55], v131 offset:51200
    ds_read_b128 v[56:59], v131 offset:8448
    ds_read_b128 v[60:63], v131 offset:8960
    ds_read_b128 v[64:67], v131 offset:25344
    ds_read_b128 v[68:71], v131 offset:25856
    ds_read_b128 v[72:75], v131 offset:42240
    ds_read_b128 v[76:79], v131 offset:42752
    ds_read_b128 v[80:83], v131 offset:59136
    ds_read_b128 v[84:87], v131 offset:59648
    s_mul_i32 s50, s83, 57344
    s_lshl_b32 s51, s84, 7
    s_add_u32 s50, s50, s51
    s_waitcnt lgkmcnt(13)
    v_pk_add_f32 v[24:25], v[24:25], v[32:33]
    s_waitcnt lgkmcnt(9)
    v_pk_add_f32 v[40:41], v[40:41], v[48:49]
    v_pk_add_f32 v[26:27], v[26:27], v[34:35]
    v_pk_add_f32 v[42:43], v[42:43], v[50:51]
    v_lshlrev_b32_e64 v32, 16, v120
    v_and_b32 v33, 0xffff0000, v120
    v_lshlrev_b32_e64 v34, 16, v121
    v_and_b32 v35, 0xffff0000, v121
    v_pk_add_f32 v[24:25], v[24:25], v[40:41]
    v_pk_add_f32 v[26:27], v[26:27], v[42:43]
    v_pk_add_f32 v[24:25], v[24:25], v[32:33]
    v_pk_add_f32 v[26:27], v[26:27], v[34:35]
    v_cvt_pk_bf16_f32 v120, v24, v25
    v_cvt_pk_bf16_f32 v121, v26, v27
    v_pk_add_f32 v[28:29], v[28:29], v[36:37]
    s_waitcnt lgkmcnt(8)
    v_pk_add_f32 v[44:45], v[44:45], v[52:53]
    v_pk_add_f32 v[30:31], v[30:31], v[38:39]
    v_pk_add_f32 v[46:47], v[46:47], v[54:55]
    v_lshlrev_b32 v36, 16, v122
    v_and_b32 v37, 0xffff0000, v122
    v_lshlrev_b32_e64 v38, 16, v123
    v_and_b32 v39, 0xffff0000, v123
    v_pk_add_f32 v[28:29], v[28:29], v[44:45]
    v_pk_add_f32 v[30:31], v[30:31], v[46:47]
    v_pk_add_f32 v[28:29], v[28:29], v[36:37]
    v_pk_add_f32 v[30:31], v[30:31], v[38:39]
    v_cvt_pk_bf16_f32 v122, v28, v29
    v_cvt_pk_bf16_f32 v123, v30, v31
    buffer_store_dwordx4 v[120:123], v129, s[40:43], s50 offen
    s_waitcnt lgkmcnt(5)
    v_pk_add_f32 v[56:57], v[56:57], v[64:65]
    s_waitcnt lgkmcnt(1)
    v_pk_add_f32 v[72:73], v[72:73], v[80:81]
    v_pk_add_f32 v[58:59], v[58:59], v[66:67]
    v_pk_add_f32 v[74:75], v[74:75], v[82:83]
    v_lshlrev_b32_e64 v64, 16, v124
    v_and_b32 v65, 0xffff0000, v124
    v_lshlrev_b32_e64 v66, 16, v125
    v_and_b32 v67, 0xffff0000, v125
    v_pk_add_f32 v[56:57], v[56:57], v[72:73]
    v_pk_add_f32 v[58:59], v[58:59], v[74:75]
    v_pk_add_f32 v[56:57], v[56:57], v[64:65]
    v_pk_add_f32 v[58:59], v[58:59], v[66:67]
    v_cvt_pk_bf16_f32 v124, v56, v57
    v_cvt_pk_bf16_f32 v125, v58, v59
    v_pk_add_f32 v[60:61], v[60:61], v[68:69]
    s_waitcnt lgkmcnt(0)
    v_pk_add_f32 v[76:77], v[76:77], v[84:85]
    v_pk_add_f32 v[62:63], v[62:63], v[70:71]
    v_pk_add_f32 v[78:79], v[78:79], v[86:87]
    v_lshlrev_b32 v68, 16, v126
    v_and_b32 v69, 0xffff0000, v126
    v_lshlrev_b32_e64 v70, 16, v127
    v_and_b32 v71, 0xffff0000, v127
    v_pk_add_f32 v[60:61], v[60:61], v[76:77]
    v_pk_add_f32 v[62:63], v[62:63], v[78:79]
    v_pk_add_f32 v[60:61], v[60:61], v[68:69]
    v_pk_add_f32 v[62:63], v[62:63], v[70:71]
    v_cvt_pk_bf16_f32 v126, v60, v61
    v_cvt_pk_bf16_f32 v127, v62, v63
    s_add_u32 s50, s50, 28672
    buffer_store_dwordx4 v[124:127], v129, s[40:43], s50 offen
    s_endpgm
k_tail_2:
    s_waitcnt vmcnt(0) lgkmcnt(0)
    s_nop 15
    s_nop 0
    v_fma_f32 v224, v15, v224, v168
    v_fma_f32 v225, v15, v225, v169
    v_fma_f32 v226, v15, v226, v170
    v_fma_f32 v227, v15, v227, v171
    v_fma_f32 v228, v15, v228, v172
    v_fma_f32 v229, v15, v229, v173
    v_fma_f32 v230, v15, v230, v174
    v_fma_f32 v231, v15, v231, v175
    v_fma_f32 v232, v15, v232, v176
    v_fma_f32 v233, v15, v233, v177
    v_fma_f32 v234, v15, v234, v178
    v_fma_f32 v235, v15, v235, v179
    v_fma_f32 v236, v15, v236, v180
    v_fma_f32 v237, v15, v237, v181
    v_fma_f32 v238, v15, v238, v182
    v_fma_f32 v239, v15, v239, v183
    v_mul_f32 v240, v224, v16
    v_mul_f32 v241, v225, v16
    v_mul_f32 v242, v226, v16
    v_mul_f32 v243, v227, v16
    v_mul_f32 v244, v228, v16
    v_mul_f32 v245, v229, v16
    v_mul_f32 v246, v230, v16
    v_mul_f32 v247, v231, v16
    v_exp_f32 v240, v240
    v_exp_f32 v241, v241
    v_exp_f32 v242, v242
    v_exp_f32 v243, v243
    v_exp_f32 v244, v244
    v_exp_f32 v245, v245
    v_exp_f32 v246, v246
    v_exp_f32 v247, v247
    v_mul_f32 v224, v224, v232
    v_mul_f32 v225, v225, v233
    v_mul_f32 v226, v226, v234
    v_mul_f32 v227, v227, v235
    v_mul_f32 v228, v228, v236
    v_mul_f32 v229, v229, v237
    v_mul_f32 v230, v230, v238
    v_mul_f32 v231, v231, v239
    v_fma_f32 v240, v240, v17, v17
    v_fma_f32 v241, v241, v17, v17
    v_fma_f32 v242, v242, v17, v17
    v_fma_f32 v243, v243, v17, v17
    v_fma_f32 v244, v244, v17, v17
    v_fma_f32 v245, v245, v17, v17
    v_fma_f32 v246, v246, v17, v17
    v_fma_f32 v247, v247, v17, v17
    v_rcp_f32 v240, v240
    v_rcp_f32 v241, v241
    v_rcp_f32 v242, v242
    v_rcp_f32 v243, v243
    v_rcp_f32 v244, v244
    v_rcp_f32 v245, v245
    v_rcp_f32 v246, v246
    v_rcp_f32 v247, v247
    v_mul_f32 v224, v224, v240
    v_mul_f32 v225, v225, v241
    v_mul_f32 v226, v226, v242
    v_mul_f32 v227, v227, v243
    v_mul_f32 v228, v228, v244
    v_mul_f32 v229, v229, v245
    v_mul_f32 v230, v230, v246
    v_mul_f32 v231, v231, v247
    v_cvt_pk_bf16_f32 v248, v224, v225
    v_cvt_pk_bf16_f32 v249, v226, v227
    v_cvt_pk_bf16_f32 v250, v228, v229
    v_cvt_pk_bf16_f32 v251, v230, v231
    s_add_u32 s50, s95, 40960
    buffer_store_dwordx4 v[248:251], v6, s[32:35], s50 offen sc1
    ds_read_b128 v[224:227], v12 offset:768
    ds_read_b128 v[228:231], v12 offset:800
    ds_read_b128 v[232:235], v12 offset:832
    ds_read_b128 v[236:239], v12 offset:864
    s_waitcnt lgkmcnt(3)
    v_fma_f32 v224, v15, v224, v136
    v_fma_f32 v225, v15, v225, v137
    v_fma_f32 v226, v15, v226, v138
    v_fma_f32 v227, v15, v227, v139
    s_waitcnt lgkmcnt(2)
    v_fma_f32 v228, v15, v228, v140
    v_fma_f32 v229, v15, v229, v141
    v_fma_f32 v230, v15, v230, v142
    v_fma_f32 v231, v15, v231, v143
    s_waitcnt lgkmcnt(1)
    v_fma_f32 v232, v15, v232, v144
    v_fma_f32 v233, v15, v233, v145
    v_fma_f32 v234, v15, v234, v146
    v_fma_f32 v235, v15, v235, v147
    s_waitcnt lgkmcnt(0)
    v_fma_f32 v236, v15, v236, v148
    v_fma_f32 v237, v15, v237, v149
    v_fma_f32 v238, v15, v238, v150
    v_fma_f32 v239, v15, v239, v151
    v_mul_f32 v240, v224, v16
    v_mul_f32 v241, v225, v16
    v_mul_f32 v242, v226, v16
    v_mul_f32 v243, v227, v16
    v_mul_f32 v244, v228, v16
    v_mul_f32 v245, v229, v16
    v_mul_f32 v246, v230, v16
    v_mul_f32 v247, v231, v16
    v_exp_f32 v240, v240
    v_exp_f32 v241, v241
    v_exp_f32 v242, v242
    v_exp_f32 v243, v243
    v_exp_f32 v244, v244
    v_exp_f32 v245, v245
    v_exp_f32 v246, v246
    v_exp_f32 v247, v247
    v_mul_f32 v224, v224, v232
    v_mul_f32 v225, v225, v233
    v_mul_f32 v226, v226, v234
    v_mul_f32 v227, v227, v235
    v_mul_f32 v228, v228, v236
    v_mul_f32 v229, v229, v237
    v_mul_f32 v230, v230, v238
    v_mul_f32 v231, v231, v239
    v_fma_f32 v240, v240, v17, v17
    v_fma_f32 v241, v241, v17, v17
    v_fma_f32 v242, v242, v17, v17
    v_fma_f32 v243, v243, v17, v17
    v_fma_f32 v244, v244, v17, v17
    v_fma_f32 v245, v245, v17, v17
    v_fma_f32 v246, v246, v17, v17
    v_fma_f32 v247, v247, v17, v17
    v_rcp_f32 v240, v240
    v_rcp_f32 v241, v241
    v_rcp_f32 v242, v242
    v_rcp_f32 v243, v243
    v_rcp_f32 v244, v244
    v_rcp_f32 v245, v245
    v_rcp_f32 v246, v246
    v_rcp_f32 v247, v247
    v_mul_f32 v224, v224, v240
    v_mul_f32 v225, v225, v241
    v_mul_f32 v226, v226, v242
    v_mul_f32 v227, v227, v243
    v_mul_f32 v228, v228, v244
    v_mul_f32 v229, v229, v245
    v_mul_f32 v230, v230, v246
    v_mul_f32 v231, v231, v247
    v_cvt_pk_bf16_f32 v248, v224, v225
    v_cvt_pk_bf16_f32 v249, v226, v227
    v_cvt_pk_bf16_f32 v250, v228, v229
    v_cvt_pk_bf16_f32 v251, v230, v231
    s_add_u32 s50, s95, 49152
    buffer_store_dwordx4 v[248:251], v6, s[32:35], s50 offen sc1
k_end_1:
    s_endpgm
.section .rodata,"a"
.p2align 6
.amdhsa_kernel sequential_preLN__sliding_local_dilated__glu_gated_swiglu__prompt_kernel
  .amdhsa_next_free_vgpr 512
  .amdhsa_next_free_sgpr 102
  .amdhsa_accum_offset 256
  .amdhsa_group_segment_fixed_size 0
  .amdhsa_kernarg_size 80
  .amdhsa_user_sgpr_count 2
  .amdhsa_user_sgpr_kernarg_segment_ptr 1
  .amdhsa_system_sgpr_workgroup_id_x 1
.end_amdhsa_kernel
```
